```python
import torch

def _softmax(x, axis=-1):
    return torch.softmax(x, dim=axis)
def _gelu(x):
    return torch.nn.functional.gelu(x, approximate="tanh")
def _silu(x):
    return torch.nn.functional.silu(x)
def _sigmoid(x):
    return torch.sigmoid(x)
def _layernorm(x, axis=-1, eps=1e-5):
    m = x.mean(dim=axis, keepdim=True)
    v = x.var(dim=axis, keepdim=True, unbiased=False)
    return (x - m) / torch.sqrt(v + eps)
def _scatter_add(tgt, idx, src, axis=0):
    return tgt.clone().index_add_(axis, idx, src)
def _segment_sum(src, seg, n):
    out = torch.zeros((n,) + src.shape[1:], dtype=src.dtype)
    return out.index_add_(0, seg, src)
def _pad(x, pw):
    flat = tuple(v for pair in reversed(pw) for v in pair)
    return torch.nn.functional.pad(x, flat)

kernel_name = 'parallel_sum__softmax_full_mha__dense_activation_relu__prompt'

def setup_inputs():

    _w = (lambda a: (lambda t: t.to(torch.bfloat16) if t.is_floating_point() else t)(torch.as_tensor(a)))
    def _A_setup():
        B, S, D = 1, 2048, 640
        return {
            "x": _w((lambda *s: torch.randn(*s, dtype=torch.bfloat16) * 0.05)(B, S, D)),
            "wqkv": _w((lambda *s: torch.randn(*s, dtype=torch.bfloat16) * 0.2)(D, 3 * D)),
            "wo": _w((lambda *s: torch.randn(*s, dtype=torch.bfloat16) * 0.1)(D, D)),
        }
    _A_in = _A_setup()

    def _B_setup():
        B, S, D, Dff = 1, 2048, 640, 1728
        return {
            "x": _w((lambda *s: torch.randn(*s, dtype=torch.bfloat16) * 0.05)(B, S, D)),
            "w1": _w((lambda *s: torch.randn(*s, dtype=torch.bfloat16) * 0.2)(D, Dff)),
            "w2": _w((lambda *s: torch.randn(*s, dtype=torch.bfloat16) * 0.2)(Dff, D)),
        }
    _B_in = _B_setup()

    return {
        "A_x": _A_in["x"],
        "A_wqkv": _A_in["wqkv"],
        "A_wo": _A_in["wo"],
        "B_x": _B_in["x"],
        "B_w1": _B_in["w1"],
        "B_w2": _B_in["w2"],
    }

def reference(A_x, A_wqkv, A_wo, B_x, B_w1, B_w2):
    def _A_ref(x, wqkv, wo):
        B, S, D = x.shape
        H = 32; Dh = D // H
        qkv = (lambda x, *d: x.permute(*d))((x @ wqkv).reshape(B, S, 3, H, Dh), 2, 0, 3, 1, 4)
        q, k, v = qkv[0], qkv[1], qkv[2]
        scale = Dh ** -0.5
        scores = torch.einsum("bhqd,bhkd->bhqk", q, k) * scale
        p = _softmax(scores, axis=-1)
        o = torch.einsum("bhqk,bhkd->bhqd", p, v)
        return (lambda x, *d: x.permute(*d))(o, 0, 2, 1, 3).reshape(B, S, D) @ wo

    def _B_ref(x, w1, w2):
        h = torch.einsum("bsd,df->bsf", x, w1)
        zero = torch.zeros_like(h)
        h = torch.maximum(h, zero)
        return torch.einsum("bsf,fd->bsd", h, w2)

    x = A_x
    xn = _layernorm(x, axis=-1)
    return x + _A_ref(xn, A_wqkv, A_wo) + _B_ref(xn, B_w1, B_w2)
```

```asm
; @launch kernel=proj_kernel grid=(256,1,1) block=(512,1,1) lds=163840
; @launch kernel=attn_kernel grid=(256,1,1) block=(768,1,1) lds=159808
.amdgcn_target "amdgcn-amd-amdhsa--gfx950"
.text
.globl proj_kernel
.p2align 8
.type proj_kernel,@function
proj_kernel:
    s_cmp_ge_u32 s2, 256
    s_cbranch_scc1 k1_exit
    s_load_dwordx8 s[4:11], s[0:1], 0
    s_load_dwordx4 s[12:15], s[0:1], 32
    s_load_dwordx2 s[16:17], s[0:1], 64
    s_getpc_b64 s[96:97]
pf_k1a:
    v_lshlrev_b32 v60, 7, v0
    v_min_u32 v60, code_end-pf_k1a-4, v60
    v_mov_b32 v63, s97
    v_add_co_u32 v62, vcc, s96, v60
    v_addc_co_u32 v63, vcc, 0, v63, vcc
    global_load_dword v60, v[62:63], off
    v_lshrrev_b32 v40, 6, v0
    v_and_b32 v46, 63, v0
    s_bfe_u32 s36, s2, 0x20003
    v_readfirstlane_b32 s32, v40
    s_and_b32 s35, s2, 3
    s_lshl2_add_u32 s33, s35, s36
    s_lshr_b32 s37, s2, 5
    s_and_b32 s34, s2, 4
    s_lshl1_add_u32 s34, s34, s37
    s_cmp_eq_u32 s34, 15
    s_cbranch_scc1 k1_relay
    s_cmp_lt_u32 s32, 4
    s_cbranch_scc1 k1_cons
    s_and_b32 s39, s2, 7
    s_sub_u32 s40, s32, 4
    v_lshrrev_b32 v41, 3, v46
    v_and_b32 v42, 7, v46
    s_lshl2_add_u32 s38, s33, s40
    s_lshl_b32 s48, s40, 12
    s_mul_i32 s45, s38, 40960
    s_add_u32 s46, s45, 1280
    s_lshl_b32 s38, s39, 7
    s_add_u32 s44, s45, s38
    v_lshrrev_b32 v40, 4, v46
    v_xor_b32 v45, v42, v40
    v_lshlrev_b32 v45, 4, v45
    v_mul_u32_u24 v43, 1280, v41
    v_add_u32 v8, v43, v45
    v_xor_b32 v45, 64, v45
    v_add_u32 v9, v43, v45
    v_add_u32 v9, 10240, v9
    s_waitcnt lgkmcnt(0)
    s_mov_b32 s20, s4
    s_mov_b32 s21, s5
    s_mov_b32 s22, 2621440
    s_mov_b32 s23, 0x00020000
    s_mov_b32 m0, s48
    s_add_u32 s36, s44, 20480
    buffer_load_dwordx4 v8, s[20:23], s44 offen lds
    s_add_u32 m0, s48, 1024
    s_add_u32 s35, s44, 128
    buffer_load_dwordx4 v9, s[20:23], s44 offen lds
    s_add_u32 m0, s48, 2048
    s_cmp_eq_u32 s35, s46
    buffer_load_dwordx4 v8, s[20:23], s36 offen lds
    s_cselect_b32 s44, s45, s35
    s_add_u32 m0, s48, 3072
    s_add_u32 s48, s48, 16384
    buffer_load_dwordx4 v9, s[20:23], s36 offen lds
    s_and_b32 s48, s48, 0xffff
    s_lshl_b32 s47, s40, 10
    s_add_u32 s47, s47, 65536
    v_lshl_add_u32 v44, s40, 3, v41
    v_bfe_u32 v43, v46, 4, 1
    s_and_b32 s35, s40, 1
    v_lshl_or_b32 v43, s35, 1, v43
    v_lshlrev_b32 v43, 1, v43
    v_xor_b32 v43, v42, v43
    s_sub_u32 s35, s34, 5
    s_cmp_lt_u32 s35, 7
    s_cselect_b32 s24, s12, s6
    s_cselect_b32 s25, s13, s7
    s_movk_i32 s36, 3840
    s_cselect_b32 s36, 3456, s36
    s_cselect_b32 s37, s35, s34
    s_sub_u32 s38, s34, 7
    s_cmp_ge_u32 s34, 12
    s_cselect_b32 s37, s38, s37
    s_lshl_b32 s37, s37, 9
    v_lshl_add_u32 v43, v43, 4, s37
    v_mad_u32_u24 v4, s36, v44, v43
    s_lshl_b32 s43, s36, 5
    s_mul_i32 s42, s36, 640
    s_mul_i32 s41, s39, s43
    s_lshl_b32 s41, s41, 1
    s_mov_b32 s26, s42
    s_mov_b32 s27, 0x00020000
    v_add_u32 v5, 128, v4
    s_add_u32 s35, s37, 256
    s_cmp_lt_u32 s35, s36
    s_cselect_b32 s35, 256, 0x40000000
    v_add_u32 v6, s35, v4
    s_add_u32 s35, s37, 384
    s_cmp_lt_u32 s35, s36
    s_cselect_b32 s35, 384, 0x40000000
    v_add_u32 v7, s35, v4
    s_add_u32 m0, s47, 0
    s_nop 0
    buffer_load_dwordx4 v4, s[24:27], s41 offen lds
    s_add_u32 m0, s47, 4096
    s_nop 0
    buffer_load_dwordx4 v5, s[24:27], s41 offen lds
    s_add_u32 m0, s47, 8192
    s_nop 0
    buffer_load_dwordx4 v6, s[24:27], s41 offen lds
    s_add_u32 m0, s47, 12288
    s_add_u32 s35, s41, s43
    buffer_load_dwordx4 v7, s[24:27], s41 offen lds
    s_mov_b32 s41, s35
    s_add_u32 m0, s47, 16384
    s_nop 0
    buffer_load_dwordx4 v4, s[24:27], s41 offen lds
    s_add_u32 m0, s47, 20480
    s_nop 0
    buffer_load_dwordx4 v5, s[24:27], s41 offen lds
    s_add_u32 m0, s47, 24576
    s_add_u32 s36, s47, 32768
    buffer_load_dwordx4 v6, s[24:27], s41 offen lds
    s_add_u32 m0, s47, 28672
    s_add_u32 s35, s41, s43
    buffer_load_dwordx4 v7, s[24:27], s41 offen lds
    s_cmp_eq_u32 s35, s42
    s_cselect_b32 s41, 0, s35
    s_cmp_ge_u32 s36, 163840
    s_cselect_b32 s35, 98304, 0
    s_sub_u32 s47, s36, s35
    s_mov_b32 m0, s48
    s_add_u32 s36, s44, 20480
    buffer_load_dwordx4 v8, s[20:23], s44 offen lds
    s_add_u32 m0, s48, 1024
    s_add_u32 s35, s44, 128
    buffer_load_dwordx4 v9, s[20:23], s44 offen lds
    s_add_u32 m0, s48, 2048
    s_cmp_eq_u32 s35, s46
    buffer_load_dwordx4 v8, s[20:23], s36 offen lds
    s_cselect_b32 s44, s45, s35
    s_add_u32 m0, s48, 3072
    s_add_u32 s48, s48, 16384
    buffer_load_dwordx4 v9, s[20:23], s36 offen lds
    s_and_b32 s48, s48, 0xffff
    s_add_u32 m0, s47, 0
    s_nop 0
    buffer_load_dwordx4 v4, s[24:27], s41 offen lds
    s_add_u32 m0, s47, 4096
    s_nop 0
    buffer_load_dwordx4 v5, s[24:27], s41 offen lds
    s_add_u32 m0, s47, 8192
    s_nop 0
    buffer_load_dwordx4 v6, s[24:27], s41 offen lds
    s_add_u32 m0, s47, 12288
    s_add_u32 s35, s41, s43
    buffer_load_dwordx4 v7, s[24:27], s41 offen lds
    s_mov_b32 s41, s35
    s_add_u32 m0, s47, 16384
    s_nop 0
    buffer_load_dwordx4 v4, s[24:27], s41 offen lds
    s_add_u32 m0, s47, 20480
    s_nop 0
    buffer_load_dwordx4 v5, s[24:27], s41 offen lds
    s_add_u32 m0, s47, 24576
    s_add_u32 s36, s47, 32768
    buffer_load_dwordx4 v6, s[24:27], s41 offen lds
    s_add_u32 m0, s47, 28672
    s_add_u32 s35, s41, s43
    buffer_load_dwordx4 v7, s[24:27], s41 offen lds
    s_cmp_eq_u32 s35, s42
    s_cselect_b32 s41, 0, s35
    s_cmp_ge_u32 s36, 163840
    s_cselect_b32 s35, 98304, 0
    s_sub_u32 s47, s36, s35
    s_mov_b32 s49, 0
k1_ploop:
    s_waitcnt vmcnt(12)
    s_barrier
    s_mov_b32 m0, s48
    s_add_u32 s36, s44, 20480
    buffer_load_dwordx4 v8, s[20:23], s44 offen lds
    s_add_u32 m0, s48, 1024
    s_add_u32 s35, s44, 128
    buffer_load_dwordx4 v9, s[20:23], s44 offen lds
    s_add_u32 m0, s48, 2048
    s_cmp_eq_u32 s35, s46
    buffer_load_dwordx4 v8, s[20:23], s36 offen lds
    s_cselect_b32 s44, s45, s35
    s_add_u32 m0, s48, 3072
    s_add_u32 s48, s48, 16384
    buffer_load_dwordx4 v9, s[20:23], s36 offen lds
    s_and_b32 s48, s48, 0xffff
    s_add_u32 m0, s47, 0
    s_nop 0
    buffer_load_dwordx4 v4, s[24:27], s41 offen lds
    s_add_u32 m0, s47, 4096
    s_nop 0
    buffer_load_dwordx4 v5, s[24:27], s41 offen lds
    s_add_u32 m0, s47, 8192
    s_nop 0
    buffer_load_dwordx4 v6, s[24:27], s41 offen lds
    s_add_u32 m0, s47, 12288
    s_add_u32 s35, s41, s43
    buffer_load_dwordx4 v7, s[24:27], s41 offen lds
    s_mov_b32 s41, s35
    s_add_u32 m0, s47, 16384
    s_nop 0
    buffer_load_dwordx4 v4, s[24:27], s41 offen lds
    s_add_u32 m0, s47, 20480
    s_nop 0
    buffer_load_dwordx4 v5, s[24:27], s41 offen lds
    s_add_u32 m0, s47, 24576
    s_add_u32 s36, s47, 32768
    buffer_load_dwordx4 v6, s[24:27], s41 offen lds
    s_add_u32 m0, s47, 28672
    s_add_u32 s35, s41, s43
    buffer_load_dwordx4 v7, s[24:27], s41 offen lds
    s_cmp_eq_u32 s35, s42
    s_cselect_b32 s41, 0, s35
    s_cmp_ge_u32 s36, 163840
    s_cselect_b32 s35, 98304, 0
    s_sub_u32 s47, s36, s35
    s_add_u32 s49, s49, 1
    s_cmp_lt_u32 s49, 8
    s_cbranch_scc1 k1_ploop
    s_waitcnt vmcnt(12)
    s_barrier
    s_waitcnt vmcnt(0)
    s_barrier
    s_add_u32 s28, s16, 14942208
    s_addc_u32 s29, s17, 0
    s_mov_b32 s30, 2621440
    s_mov_b32 s31, 0x00020000
    s_mul_i32 s35, s33, 15
    s_add_u32 s35, s35, s34
    s_lshl2_add_u32 s35, s35, s40
    s_mul_i32 s35, s35, 3072
    v_lshlrev_b32 v16, 4, v46
    v_mov_b32 v12, -1
    v_mov_b32 v13, -1
    v_mov_b32 v14, -1
    v_mov_b32 v15, -1
    buffer_store_dwordx4 v[12:15], v16, s[28:31], s35 offen offset:0 sc1
    buffer_store_dwordx4 v[12:15], v16, s[28:31], s35 offen offset:1024 sc1
    buffer_store_dwordx4 v[12:15], v16, s[28:31], s35 offen offset:2048 sc1
    s_endpgm
k1_cons:
    s_setprio 2
    v_and_b32 v41, 15, v46
    v_lshrrev_b32 v40, 4, v46
    v_lshrrev_b32 v42, 1, v41
    v_xor_b32 v42, v42, v40
    v_lshlrev_b32 v42, 4, v42
    v_lshl_add_u32 v42, v41, 7, v42
    s_lshl_b32 s35, s32, 12
    s_add_u32 s35, s35, 49152
    v_add_u32 v0, s35, v42
    v_xor_b32 v1, 4096, v0
    v_xor_b32 v2, 8192, v0
    v_xor_b32 v3, 12288, v0
    v_xor_b32 v4, 64, v0
    v_xor_b32 v5, 4160, v0
    v_xor_b32 v6, 8256, v0
    v_xor_b32 v7, 12352, v0
    v_bfe_u32 v42, v46, 2, 2
    v_lshl_add_u32 v42, v40, 3, v42
    v_lshlrev_b32 v42, 7, v42
    v_bfe_u32 v43, v46, 3, 2
    v_lshl_add_u32 v42, v43, 5, v42
    v_and_b32 v43, 3, v46
    v_lshl_add_u32 v42, v43, 3, v42
    s_add_u32 s35, s35, 81920
    v_add_u32 v8, s35, v42
    v_xor_b32 v9, 32, v8
    v_xor_b32 v10, 64, v8
    v_xor_b32 v11, 96, v8
    v_and_b32 v42, 1, v46
    v_mul_u32_u24 v42, 0xaaaa, v42
    v_add_u32 v13, 0x4444, v42
    v_xor_b32 v42, v40, v46
    v_bfe_u32 v42, v42, 1, 1
    v_add_u32 v42, -1, v42
    v_and_b32 v16, 0x3f803f80, v42
    v_and_b32 v17, 0x3f803f80, v42
    v_and_b32 v18, 0x3f803f80, v42
    v_and_b32 v19, 0x3f803f80, v42
    s_lshl_b32 s35, s32, 9
    s_add_u32 s35, s35, 49152
    v_lshl_add_u32 v56, v41, 4, s35
    v_xor_b32 v57, 512, v56
    v_xor_b32 v58, 1024, v56
    v_xor_b32 v59, 1536, v56
    v_lshrrev_b32 v44, 1, v40
    v_lshl_add_u32 v15, v44, 8, v56
    v_and_b32 v43, 1, v40
    v_mov_b32 v20, 0
    v_mov_b32 v21, 0
    v_mov_b32 v22, 0
    v_mov_b32 v23, 0
    v_mov_b32 v24, 0
    v_mov_b32 v25, 0
    v_mov_b32 v26, 0
    v_mov_b32 v27, 0
    v_mov_b32 v28, 0
    v_mov_b32 v29, 0
    v_mov_b32 v30, 0
    v_mov_b32 v31, 0
    v_mov_b32 v32, 0
    v_mov_b32 v33, 0
    v_mov_b32 v34, 0
    v_mov_b32 v35, 0
    v_mov_b32 v36, 0
    v_mov_b32 v37, 0
    v_mov_b32 v38, 0
    v_mov_b32 v39, 0
    ds_write_b128 v4, v[20:23] offset:0
    ds_write_b128 v4, v[20:23] offset:2048
    ds_write_b128 v5, v[20:23] offset:0
    ds_write_b128 v5, v[20:23] offset:2048
    ds_write_b128 v6, v[20:23] offset:0
    ds_write_b128 v6, v[20:23] offset:2048
    ds_write_b128 v7, v[20:23] offset:0
    ds_write_b128 v7, v[20:23] offset:2048
    ds_write_b64 v8, v[20:21] offset:16384
    ds_write_b64 v8, v[20:21] offset:16896
    ds_write_b64 v9, v[20:21] offset:16384
    ds_write_b64 v9, v[20:21] offset:16896
    ds_write_b64 v10, v[20:21] offset:16384
    ds_write_b64 v10, v[20:21] offset:16896
    ds_write_b64 v11, v[20:21] offset:16384
    ds_write_b64 v11, v[20:21] offset:16896
    v_mfma_f32_32x32x16_bf16 v[64:79], v[20:23], v[20:23], 0
    v_mfma_f32_32x32x16_bf16 v[80:95], v[20:23], v[20:23], 0
    v_mfma_f32_32x32x16_bf16 v[96:111], v[20:23], v[20:23], 0
    v_mfma_f32_32x32x16_bf16 v[112:127], v[20:23], v[20:23], 0
    v_mfma_f32_32x32x16_bf16 v[128:143], v[20:23], v[20:23], 0
    v_mfma_f32_32x32x16_bf16 v[144:159], v[20:23], v[20:23], 0
    v_mfma_f32_32x32x16_bf16 v[160:175], v[20:23], v[20:23], 0
    v_mfma_f32_32x32x16_bf16 v[176:191], v[20:23], v[20:23], 0
    v_mfma_f32_32x32x16_bf16 v[192:207], v[20:23], v[20:23], 0
    v_mfma_f32_32x32x16_bf16 v[208:223], v[20:23], v[20:23], 0
    v_mfma_f32_32x32x16_bf16 v[224:239], v[20:23], v[20:23], 0
    v_mfma_f32_32x32x16_bf16 v[240:255], v[20:23], v[20:23], 0
    s_lshl2_add_u32 s44, s34, s32
    s_waitcnt lgkmcnt(0)
    s_mov_b32 s28, s16
    s_mov_b32 s29, s17
    s_mov_b32 s30, 14942208
    s_mov_b32 s31, 0x00020000
    s_cmp_lt_u32 s34, 5
    s_cbranch_scc1 k1_qk
    s_cmp_lt_u32 s34, 12
    s_cbranch_scc0 k1_v
    s_cmp_lt_u32 s44, 47
    s_cselect_b32 s30, s30, 0
    v_lshlrev_b32 v43, 8, v43
    v_lshl_add_u32 v12, v41, 4, v43
    v_mul_u32_u24 v45, 512, v44
    v_add_u32 v12, v12, v45
    s_mul_i32 s36, s44, 2048
    s_add_u32 s36, s36, 7823360
    s_xor_b32 s35, s32, 0
    s_lshl2_add_u32 s35, s33, s35
    s_mul_i32 s35, s35, 110592
    s_add_u32 s48, s35, s36
    s_add_u32 s49, s48, 55296
    s_xor_b32 s35, s32, 1
    s_lshl2_add_u32 s35, s33, s35
    s_mul_i32 s35, s35, 110592
    s_add_u32 s50, s35, s36
    s_add_u32 s51, s50, 55296
    s_xor_b32 s35, s32, 2
    s_lshl2_add_u32 s35, s33, s35
    s_mul_i32 s35, s35, 110592
    s_add_u32 s52, s35, s36
    s_add_u32 s53, s52, 55296
    s_xor_b32 s35, s32, 3
    s_lshl2_add_u32 s35, s33, s35
    s_mul_i32 s35, s35, 110592
    s_add_u32 s54, s35, s36
    s_add_u32 s55, s54, 55296
    s_mov_b32 vcc_lo, -1
    s_mov_b32 vcc_hi, 0
    s_mov_b32 s36, 16384
    s_mov_b32 s37, 32768
    s_mov_b32 s40, -2
    s_mov_b32 s41, 1
.p2align 6
k1_loop_h:
    s_waitcnt lgkmcnt(4)
    v_mfma_f32_16x16x32_bf16 v[128:131], v[96:99], v[64:67], v[128:131]
    ds_read_b64_tr_b16 v[112:113], v8 offset:16384
    s_add_u32 s40, s40, 1
    v_mfma_f32_16x16x32_bf16 v[132:135], v[100:103], v[64:67], v[132:135]
    ds_read_b64_tr_b16 v[114:115], v8 offset:16896
    s_and_b32 s35, s40, 3
    v_mfma_f32_16x16x32_bf16 v[136:139], v[104:107], v[64:67], v[136:139]
    ds_read_b64_tr_b16 v[116:117], v9 offset:16384
    s_cmp_eq_u32 s35, 3
    v_mfma_f32_16x16x32_bf16 v[140:143], v[108:111], v[64:67], v[140:143]
    ds_read_b64_tr_b16 v[118:119], v9 offset:16896
    s_cselect_b32 s42, 4294918144, s36
    v_mfma_f32_16x16x32_bf16 v[144:147], v[96:99], v[68:71], v[144:147]
    ds_read_b64_tr_b16 v[120:121], v10 offset:16384
    s_add_u32 s41, s41, 1
    v_mfma_f32_16x16x32_bf16 v[148:151], v[100:103], v[68:71], v[148:151]
    ds_read_b64_tr_b16 v[122:123], v10 offset:16896
    s_cmp_eq_u32 s41, 2
    v_mfma_f32_16x16x32_bf16 v[152:155], v[104:107], v[68:71], v[152:155]
    ds_read_b64_tr_b16 v[124:125], v11 offset:16384
    s_cselect_b32 s43, 4294901760, s37
    v_mfma_f32_16x16x32_bf16 v[156:159], v[108:111], v[68:71], v[156:159]
    ds_read_b64_tr_b16 v[126:127], v11 offset:16896
    s_cselect_b32 s41, -1, s41
    v_smfmac_f32_16x16x64_bf16 v[28:31], v[16:19], v[64:71], v13
    ds_read_b128 v[64:67], v4 offset:0
    v_add_u32 v0, s42, v0
    v_mfma_f32_16x16x32_bf16 v[160:163], v[96:99], v[72:75], v[160:163]
    ds_read_b128 v[68:71], v4 offset:2048
    v_add_u32 v1, s42, v1
    v_mfma_f32_16x16x32_bf16 v[164:167], v[100:103], v[72:75], v[164:167]
    v_add_u32 v2, s42, v2
    v_add_u32 v3, s42, v3
    v_mfma_f32_16x16x32_bf16 v[168:171], v[104:107], v[72:75], v[168:171]
    v_add_u32 v8, s43, v8
    v_add_u32 v9, s43, v9
    v_mfma_f32_16x16x32_bf16 v[172:175], v[108:111], v[72:75], v[172:175]
    ds_read_b128 v[72:75], v5 offset:0
    v_add_u32 v10, s43, v10
    v_smfmac_f32_16x16x64_bf16 v[20:23], v[16:19], v[96:103], v13
    v_add_u32 v11, s43, v11
    v_add_u32 v4, s42, v4
    v_mfma_f32_16x16x32_bf16 v[176:179], v[96:99], v[76:79], v[176:179]
    v_mfma_f32_16x16x32_bf16 v[180:183], v[100:103], v[76:79], v[180:183]
    v_mfma_f32_16x16x32_bf16 v[184:187], v[104:107], v[76:79], v[184:187]
    v_mfma_f32_16x16x32_bf16 v[188:191], v[108:111], v[76:79], v[188:191]
    ds_read_b128 v[76:79], v5 offset:2048
    v_add_u32 v5, s42, v5
    v_smfmac_f32_16x16x64_bf16 v[24:27], v[16:19], v[104:111], v13
    s_waitcnt lgkmcnt(3)
    v_mfma_f32_16x16x32_bf16 v[192:195], v[96:99], v[80:83], v[192:195]
    v_mfma_f32_16x16x32_bf16 v[196:199], v[100:103], v[80:83], v[196:199]
    v_mfma_f32_16x16x32_bf16 v[200:203], v[104:107], v[80:83], v[200:203]
    v_mfma_f32_16x16x32_bf16 v[204:207], v[108:111], v[80:83], v[204:207]
    ds_read_b128 v[80:83], v6 offset:0
    v_mfma_f32_16x16x32_bf16 v[208:211], v[96:99], v[84:87], v[208:211]
    v_mfma_f32_16x16x32_bf16 v[212:215], v[100:103], v[84:87], v[212:215]
    v_mfma_f32_16x16x32_bf16 v[216:219], v[104:107], v[84:87], v[216:219]
    v_mfma_f32_16x16x32_bf16 v[220:223], v[108:111], v[84:87], v[220:223]
    ds_read_b128 v[84:87], v6 offset:2048
    v_add_u32 v6, s42, v6
    v_mfma_f32_16x16x32_bf16 v[224:227], v[96:99], v[88:91], v[224:227]
    v_mfma_f32_16x16x32_bf16 v[228:231], v[100:103], v[88:91], v[228:231]
    v_mfma_f32_16x16x32_bf16 v[232:235], v[104:107], v[88:91], v[232:235]
    v_mfma_f32_16x16x32_bf16 v[236:239], v[108:111], v[88:91], v[236:239]
    ds_read_b128 v[88:91], v7 offset:0
    v_mfma_f32_16x16x32_bf16 v[240:243], v[96:99], v[92:95], v[240:243]
    v_mfma_f32_16x16x32_bf16 v[244:247], v[100:103], v[92:95], v[244:247]
    v_mfma_f32_16x16x32_bf16 v[248:251], v[104:107], v[92:95], v[248:251]
    v_mfma_f32_16x16x32_bf16 v[252:255], v[108:111], v[92:95], v[252:255]
    ds_read_b128 v[92:95], v7 offset:2048
    v_add_u32 v7, s42, v7
    v_mfma_f32_16x16x32_bf16 v[128:131], v[112:115], v[64:67], v[128:131]
    v_mfma_f32_16x16x32_bf16 v[132:135], v[116:119], v[64:67], v[132:135]
    v_mfma_f32_16x16x32_bf16 v[136:139], v[120:123], v[64:67], v[136:139]
    v_mfma_f32_16x16x32_bf16 v[140:143], v[124:127], v[64:67], v[140:143]
    s_waitcnt lgkmcnt(3)
    v_mfma_f32_16x16x32_bf16 v[144:147], v[112:115], v[68:71], v[144:147]
    v_mfma_f32_16x16x32_bf16 v[148:151], v[116:119], v[68:71], v[148:151]
    v_mfma_f32_16x16x32_bf16 v[152:155], v[120:123], v[68:71], v[152:155]
    v_mfma_f32_16x16x32_bf16 v[156:159], v[124:127], v[68:71], v[156:159]
    v_smfmac_f32_16x16x64_bf16 v[28:31], v[16:19], v[64:71], v13
    v_mfma_f32_16x16x32_bf16 v[160:163], v[112:115], v[72:75], v[160:163]
    v_mfma_f32_16x16x32_bf16 v[164:167], v[116:119], v[72:75], v[164:167]
    v_mfma_f32_16x16x32_bf16 v[168:171], v[120:123], v[72:75], v[168:171]
    v_mfma_f32_16x16x32_bf16 v[172:175], v[124:127], v[72:75], v[172:175]
    v_smfmac_f32_16x16x64_bf16 v[20:23], v[16:19], v[112:119], v13
    v_mfma_f32_16x16x32_bf16 v[176:179], v[112:115], v[76:79], v[176:179]
    s_barrier
    ds_read_b64_tr_b16 v[96:97], v8 offset:0
    v_mfma_f32_16x16x32_bf16 v[180:183], v[116:119], v[76:79], v[180:183]
    ds_read_b64_tr_b16 v[98:99], v8 offset:512
    v_mfma_f32_16x16x32_bf16 v[184:187], v[120:123], v[76:79], v[184:187]
    ds_read_b128 v[64:67], v0 offset:0
    v_mfma_f32_16x16x32_bf16 v[188:191], v[124:127], v[76:79], v[188:191]
    ds_read_b64_tr_b16 v[100:101], v9 offset:0
    v_smfmac_f32_16x16x64_bf16 v[24:27], v[16:19], v[120:127], v13
    ds_read_b64_tr_b16 v[102:103], v9 offset:512
    v_mfma_f32_16x16x32_bf16 v[192:195], v[112:115], v[80:83], v[192:195]
    ds_read_b64_tr_b16 v[104:105], v10 offset:0
    v_mfma_f32_16x16x32_bf16 v[196:199], v[116:119], v[80:83], v[196:199]
    ds_read_b64_tr_b16 v[106:107], v10 offset:512
    v_mfma_f32_16x16x32_bf16 v[200:203], v[120:123], v[80:83], v[200:203]
    ds_read_b64_tr_b16 v[108:109], v11 offset:0
    v_mfma_f32_16x16x32_bf16 v[204:207], v[124:127], v[80:83], v[204:207]
    ds_read_b64_tr_b16 v[110:111], v11 offset:512
    s_waitcnt lgkmcnt(9)
    v_mfma_f32_16x16x32_bf16 v[208:211], v[112:115], v[84:87], v[208:211]
    ds_read_b128 v[68:71], v0 offset:2048
    v_mfma_f32_16x16x32_bf16 v[212:215], v[116:119], v[84:87], v[212:215]
    ds_read_b128 v[72:75], v1 offset:0
    v_mfma_f32_16x16x32_bf16 v[216:219], v[120:123], v[84:87], v[216:219]
    ds_read_b128 v[76:79], v1 offset:2048
    v_mfma_f32_16x16x32_bf16 v[220:223], v[124:127], v[84:87], v[220:223]
    ds_read_b128 v[80:83], v2 offset:0
    v_mfma_f32_16x16x32_bf16 v[224:227], v[112:115], v[88:91], v[224:227]
    ds_read_b128 v[84:87], v2 offset:2048
    v_mfma_f32_16x16x32_bf16 v[228:231], v[116:119], v[88:91], v[228:231]
    v_mfma_f32_16x16x32_bf16 v[232:235], v[120:123], v[88:91], v[232:235]
    v_mfma_f32_16x16x32_bf16 v[236:239], v[124:127], v[88:91], v[236:239]
    ds_read_b128 v[88:91], v3 offset:0
    v_mfma_f32_16x16x32_bf16 v[240:243], v[112:115], v[92:95], v[240:243]
    v_mfma_f32_16x16x32_bf16 v[244:247], v[116:119], v[92:95], v[244:247]
    v_mfma_f32_16x16x32_bf16 v[248:251], v[120:123], v[92:95], v[248:251]
    v_mfma_f32_16x16x32_bf16 v[252:255], v[124:127], v[92:95], v[252:255]
    ds_read_b128 v[92:95], v3 offset:2048
    s_cmp_lt_i32 s40, 8
    s_cbranch_scc1 k1_loop_h
    s_waitcnt lgkmcnt(5)
    v_mfma_f32_16x16x32_bf16 v[128:131], v[96:99], v[64:67], v[128:131]
    ds_read_b128 v[40:43], v4 offset:0
    v_mfma_f32_16x16x32_bf16 v[132:135], v[100:103], v[64:67], v[132:135]
    ds_read_b128 v[44:47], v4 offset:2048
    v_mfma_f32_16x16x32_bf16 v[136:139], v[104:107], v[64:67], v[136:139]
    ds_read_b64_tr_b16 v[112:113], v8 offset:16384
    v_mfma_f32_16x16x32_bf16 v[140:143], v[108:111], v[64:67], v[140:143]
    ds_read_b64_tr_b16 v[114:115], v8 offset:16896
    v_mfma_f32_16x16x32_bf16 v[144:147], v[96:99], v[68:71], v[144:147]
    ds_read_b64_tr_b16 v[116:117], v9 offset:16384
    v_mfma_f32_16x16x32_bf16 v[148:151], v[100:103], v[68:71], v[148:151]
    ds_read_b64_tr_b16 v[118:119], v9 offset:16896
    v_mfma_f32_16x16x32_bf16 v[152:155], v[104:107], v[68:71], v[152:155]
    ds_read_b64_tr_b16 v[120:121], v10 offset:16384
    v_mfma_f32_16x16x32_bf16 v[156:159], v[108:111], v[68:71], v[156:159]
    ds_read_b64_tr_b16 v[122:123], v10 offset:16896
    v_smfmac_f32_16x16x64_bf16 v[28:31], v[16:19], v[64:71], v13
    ds_read_b64_tr_b16 v[124:125], v11 offset:16384
    v_smfmac_f32_16x16x64_bf16 v[20:23], v[16:19], v[96:103], v13
    ds_read_b64_tr_b16 v[126:127], v11 offset:16896
    v_smfmac_f32_16x16x64_bf16 v[24:27], v[16:19], v[104:111], v13
    ds_read_b128 v[48:51], v5 offset:0
    v_mfma_f32_16x16x32_bf16 v[160:163], v[96:99], v[72:75], v[160:163]
    ds_read_b128 v[52:55], v5 offset:2048
    v_mfma_f32_16x16x32_bf16 v[164:167], v[100:103], v[72:75], v[164:167]
    v_mfma_f32_16x16x32_bf16 v[168:171], v[104:107], v[72:75], v[168:171]
    v_mfma_f32_16x16x32_bf16 v[172:175], v[108:111], v[72:75], v[172:175]
    s_waitcnt lgkmcnt(4)
    v_smfmac_f32_16x16x64_bf16 v[28:31], v[16:19], v[40:47], v13
    v_smfmac_f32_16x16x64_bf16 v[20:23], v[16:19], v[112:119], v13
    s_waitcnt lgkmcnt(2)
    v_smfmac_f32_16x16x64_bf16 v[24:27], v[16:19], v[120:127], v13
    v_mfma_f32_16x16x32_bf16 v[128:131], v[112:115], v[40:43], v[128:131]
    v_mfma_f32_16x16x32_bf16 v[132:135], v[116:119], v[40:43], v[132:135]
    v_mfma_f32_16x16x32_bf16 v[136:139], v[120:123], v[40:43], v[136:139]
    v_mfma_f32_16x16x32_bf16 v[140:143], v[124:127], v[40:43], v[140:143]
    ds_read_b128 v[40:43], v6 offset:0
    v_add_f32 v28, v28, v29
    v_mfma_f32_16x16x32_bf16 v[144:147], v[112:115], v[44:47], v[144:147]
    v_add_f32 v30, v30, v31
    v_cndmask_b32 v28, v30, v28, vcc
    v_mfma_f32_16x16x32_bf16 v[148:151], v[116:119], v[44:47], v[148:151]
    v_mul_f32 v28, 0xb9cccccd, v28
    v_and_b32 v29, 0xffff0000, v28
    v_mfma_f32_16x16x32_bf16 v[152:155], v[120:123], v[44:47], v[152:155]
    v_sub_f32 v30, v28, v29
    v_cvt_pk_bf16_f32 v16, v29, v29
    v_mfma_f32_16x16x32_bf16 v[156:159], v[124:127], v[44:47], v[156:159]
    ds_read_b128 v[44:47], v6 offset:2048
    v_cvt_pk_bf16_f32 v17, v30, v30
    ds_write_b64 v15, v[16:17]
    s_waitcnt lgkmcnt(0)
    s_barrier
    v_mfma_f32_16x16x32_bf16 v[160:163], v[112:115], v[48:51], v[160:163]
    ds_read_b64 v[64:65], v56 offset:0
    v_add_f32 v20, v20, v21
    v_mfma_f32_16x16x32_bf16 v[164:167], v[116:119], v[48:51], v[164:167]
    ds_read_b64 v[68:69], v56 offset:256
    v_add_f32 v22, v22, v23
    v_mfma_f32_16x16x32_bf16 v[168:171], v[120:123], v[48:51], v[168:171]
    ds_read_b64 v[72:73], v57 offset:0
    v_add_f32 v24, v24, v25
    v_mfma_f32_16x16x32_bf16 v[172:175], v[124:127], v[48:51], v[172:175]
    ds_read_b128 v[48:51], v7 offset:0
    v_add_f32 v26, v26, v27
    v_mfma_f32_16x16x32_bf16 v[176:179], v[96:99], v[76:79], v[176:179]
    v_and_b32 v21, 0xffff0000, v20
    v_and_b32 v23, 0xffff0000, v22
    v_mfma_f32_16x16x32_bf16 v[180:183], v[100:103], v[76:79], v[180:183]
    v_and_b32 v25, 0xffff0000, v24
    v_and_b32 v27, 0xffff0000, v26
    v_mfma_f32_16x16x32_bf16 v[184:187], v[104:107], v[76:79], v[184:187]
    v_sub_f32 v20, v20, v21
    v_sub_f32 v22, v22, v23
    v_mfma_f32_16x16x32_bf16 v[188:191], v[108:111], v[76:79], v[188:191]
    ds_read_b64 v[76:77], v57 offset:256
    v_sub_f32 v24, v24, v25
    v_mfma_f32_16x16x32_bf16 v[176:179], v[112:115], v[52:55], v[176:179]
    v_sub_f32 v26, v26, v27
    v_cvt_pk_bf16_f32 v20, v21, v20
    v_mfma_f32_16x16x32_bf16 v[180:183], v[116:119], v[52:55], v[180:183]
    v_cvt_pk_bf16_f32 v22, v23, v22
    v_cvt_pk_bf16_f32 v24, v25, v24
    v_cvt_pk_bf16_f32 v26, v27, v26
    v_mov_b32 v21, v20
    v_mov_b32 v23, v22
    v_mov_b32 v25, v24
    v_mov_b32 v27, v26
    s_waitcnt lgkmcnt(4)
    v_mfma_f32_16x16x16_bf16 v[128:131], v[20:21], v[64:65], v[128:131]
    v_mfma_f32_16x16x16_bf16 v[132:135], v[22:23], v[64:65], v[132:135]
    v_mfma_f32_16x16x16_bf16 v[136:139], v[24:25], v[64:65], v[136:139]
    v_mfma_f32_16x16x16_bf16 v[140:143], v[26:27], v[64:65], v[140:143]
    s_waitcnt lgkmcnt(3)
    v_mfma_f32_16x16x16_bf16 v[144:147], v[20:21], v[68:69], v[144:147]
    v_mfma_f32_16x16x16_bf16 v[148:151], v[22:23], v[68:69], v[148:151]
    v_mfma_f32_16x16x16_bf16 v[152:155], v[24:25], v[68:69], v[152:155]
    v_mfma_f32_16x16x16_bf16 v[156:159], v[26:27], v[68:69], v[156:159]
    v_cvt_pk_bf16_f32 v128, v128, v129
    s_waitcnt lgkmcnt(2)
    v_mfma_f32_16x16x16_bf16 v[160:163], v[20:21], v[72:73], v[160:163]
    v_cvt_pk_bf16_f32 v129, v130, v131
    v_cvt_pk_bf16_f32 v130, v132, v133
    v_mfma_f32_16x16x16_bf16 v[164:167], v[22:23], v[72:73], v[164:167]
    v_cvt_pk_bf16_f32 v131, v134, v135
    v_pk_max_i16 v128, v128, 0
    v_pk_max_i16 v130, v130, 0
    v_mfma_f32_16x16x16_bf16 v[168:171], v[24:25], v[72:73], v[168:171]
    v_pk_max_i16 v129, v129, 0
    v_pk_max_i16 v131, v131, 0
    v_mfma_f32_16x16x16_bf16 v[172:175], v[26:27], v[72:73], v[172:175]
    v_cvt_pk_bf16_f32 v136, v136, v137
    v_cvt_pk_bf16_f32 v137, v138, v139
    v_permlane16_swap_b32 v128, v130
    v_mfma_f32_16x16x32_bf16 v[184:187], v[120:123], v[52:55], v[184:187]
    v_permlane16_swap_b32 v129, v131
    buffer_store_dwordx4 v[128:131], v12, s[28:31], s48 offen offset:0 sc1
    v_mfma_f32_16x16x32_bf16 v[188:191], v[124:127], v[52:55], v[188:191]
    ds_read_b128 v[52:55], v7 offset:2048
    v_cvt_pk_bf16_f32 v138, v140, v141
    v_cvt_pk_bf16_f32 v139, v142, v143
    v_pk_max_i16 v136, v136, 0
    s_waitcnt lgkmcnt(1)
    v_mfma_f32_16x16x16_bf16 v[176:179], v[20:21], v[76:77], v[176:179]
    v_pk_max_i16 v138, v138, 0
    v_pk_max_i16 v137, v137, 0
    v_pk_max_i16 v139, v139, 0
    v_mfma_f32_16x16x16_bf16 v[180:183], v[22:23], v[76:77], v[180:183]
    v_permlane16_swap_b32 v136, v138
    v_mfma_f32_16x16x16_bf16 v[184:187], v[24:25], v[76:77], v[184:187]
    v_permlane16_swap_b32 v137, v139
    buffer_store_dwordx4 v[136:139], v12, s[28:31], s48 offen offset:1024 sc1
    v_cvt_pk_bf16_f32 v144, v144, v145
    v_mfma_f32_16x16x16_bf16 v[188:191], v[26:27], v[76:77], v[188:191]
    v_cvt_pk_bf16_f32 v145, v146, v147
    v_cvt_pk_bf16_f32 v146, v148, v149
    v_mfma_f32_16x16x32_bf16 v[192:195], v[96:99], v[80:83], v[192:195]
    v_cvt_pk_bf16_f32 v147, v150, v151
    v_pk_max_i16 v144, v144, 0
    v_pk_max_i16 v146, v146, 0
    v_mfma_f32_16x16x32_bf16 v[196:199], v[100:103], v[80:83], v[196:199]
    v_pk_max_i16 v145, v145, 0
    v_pk_max_i16 v147, v147, 0
    v_cvt_pk_bf16_f32 v152, v152, v153
    v_mfma_f32_16x16x32_bf16 v[200:203], v[104:107], v[80:83], v[200:203]
    v_cvt_pk_bf16_f32 v153, v154, v155
    v_permlane16_swap_b32 v144, v146
    v_mfma_f32_16x16x32_bf16 v[204:207], v[108:111], v[80:83], v[204:207]
    ds_read_b64 v[80:81], v58 offset:0
    v_permlane16_swap_b32 v145, v147
    buffer_store_dwordx4 v[144:147], v12, s[28:31], s49 offen offset:0 sc1
    v_cvt_pk_bf16_f32 v154, v156, v157
    v_mfma_f32_16x16x32_bf16 v[192:195], v[112:115], v[40:43], v[192:195]
    v_cvt_pk_bf16_f32 v155, v158, v159
    v_pk_max_i16 v152, v152, 0
    v_mfma_f32_16x16x32_bf16 v[196:199], v[116:119], v[40:43], v[196:199]
    v_pk_max_i16 v154, v154, 0
    v_pk_max_i16 v153, v153, 0
    v_pk_max_i16 v155, v155, 0
    v_mfma_f32_16x16x32_bf16 v[200:203], v[120:123], v[40:43], v[200:203]
    v_permlane16_swap_b32 v152, v154
    v_permlane16_swap_b32 v153, v155
    v_mfma_f32_16x16x32_bf16 v[204:207], v[124:127], v[40:43], v[204:207]
    buffer_store_dwordx4 v[152:155], v12, s[28:31], s49 offen offset:1024 sc1
    v_cvt_pk_bf16_f32 v160, v160, v161
    s_waitcnt lgkmcnt(0)
    v_mfma_f32_16x16x16_bf16 v[192:195], v[20:21], v[80:81], v[192:195]
    v_cvt_pk_bf16_f32 v161, v162, v163
    v_cvt_pk_bf16_f32 v162, v164, v165
    v_cvt_pk_bf16_f32 v163, v166, v167
    v_mfma_f32_16x16x16_bf16 v[196:199], v[22:23], v[80:81], v[196:199]
    v_pk_max_i16 v160, v160, 0
    v_pk_max_i16 v162, v162, 0
    v_mfma_f32_16x16x16_bf16 v[200:203], v[24:25], v[80:81], v[200:203]
    v_pk_max_i16 v161, v161, 0
    v_pk_max_i16 v163, v163, 0
    v_cvt_pk_bf16_f32 v168, v168, v169
    v_mfma_f32_16x16x16_bf16 v[204:207], v[26:27], v[80:81], v[204:207]
    v_cvt_pk_bf16_f32 v169, v170, v171
    v_permlane16_swap_b32 v160, v162
    v_permlane16_swap_b32 v161, v163
    v_mfma_f32_16x16x32_bf16 v[208:211], v[96:99], v[84:87], v[208:211]
    buffer_store_dwordx4 v[160:163], v12, s[28:31], s50 offen offset:0 sc1
    v_cvt_pk_bf16_f32 v170, v172, v173
    v_mfma_f32_16x16x32_bf16 v[212:215], v[100:103], v[84:87], v[212:215]
    v_cvt_pk_bf16_f32 v171, v174, v175
    v_pk_max_i16 v168, v168, 0
    v_pk_max_i16 v170, v170, 0
    v_mfma_f32_16x16x32_bf16 v[216:219], v[104:107], v[84:87], v[216:219]
    v_pk_max_i16 v169, v169, 0
    v_pk_max_i16 v171, v171, 0
    v_mfma_f32_16x16x32_bf16 v[220:223], v[108:111], v[84:87], v[220:223]
    ds_read_b64 v[84:85], v58 offset:256
    v_permlane16_swap_b32 v168, v170
    v_permlane16_swap_b32 v169, v171
    v_mfma_f32_16x16x32_bf16 v[208:211], v[112:115], v[44:47], v[208:211]
    buffer_store_dwordx4 v[168:171], v12, s[28:31], s50 offen offset:1024 sc1
    v_cvt_pk_bf16_f32 v176, v176, v177
    v_cvt_pk_bf16_f32 v177, v178, v179
    v_mfma_f32_16x16x32_bf16 v[212:215], v[116:119], v[44:47], v[212:215]
    v_cvt_pk_bf16_f32 v178, v180, v181
    v_cvt_pk_bf16_f32 v179, v182, v183
    v_mfma_f32_16x16x32_bf16 v[216:219], v[120:123], v[44:47], v[216:219]
    v_pk_max_i16 v176, v176, 0
    v_pk_max_i16 v178, v178, 0
    v_pk_max_i16 v177, v177, 0
    v_mfma_f32_16x16x32_bf16 v[220:223], v[124:127], v[44:47], v[220:223]
    v_pk_max_i16 v179, v179, 0
    v_cvt_pk_bf16_f32 v184, v184, v185
    s_waitcnt lgkmcnt(0)
    v_mfma_f32_16x16x16_bf16 v[208:211], v[20:21], v[84:85], v[208:211]
    v_cvt_pk_bf16_f32 v185, v186, v187
    v_permlane16_swap_b32 v176, v178
    v_permlane16_swap_b32 v177, v179
    v_mfma_f32_16x16x16_bf16 v[212:215], v[22:23], v[84:85], v[212:215]
    buffer_store_dwordx4 v[176:179], v12, s[28:31], s51 offen offset:0 sc1
    v_cvt_pk_bf16_f32 v186, v188, v189
    v_cvt_pk_bf16_f32 v187, v190, v191
    v_mfma_f32_16x16x16_bf16 v[216:219], v[24:25], v[84:85], v[216:219]
    v_pk_max_i16 v184, v184, 0
    v_pk_max_i16 v186, v186, 0
    v_mfma_f32_16x16x16_bf16 v[220:223], v[26:27], v[84:85], v[220:223]
    v_pk_max_i16 v185, v185, 0
    v_pk_max_i16 v187, v187, 0
    v_mfma_f32_16x16x32_bf16 v[224:227], v[96:99], v[88:91], v[224:227]
    v_permlane16_swap_b32 v184, v186
    v_permlane16_swap_b32 v185, v187
    v_mfma_f32_16x16x32_bf16 v[228:231], v[100:103], v[88:91], v[228:231]
    buffer_store_dwordx4 v[184:187], v12, s[28:31], s51 offen offset:1024 sc1
    v_cvt_pk_bf16_f32 v192, v192, v193
    v_cvt_pk_bf16_f32 v193, v194, v195
    v_mfma_f32_16x16x32_bf16 v[232:235], v[104:107], v[88:91], v[232:235]
    v_cvt_pk_bf16_f32 v194, v196, v197
    v_cvt_pk_bf16_f32 v195, v198, v199
    v_pk_max_i16 v192, v192, 0
    v_mfma_f32_16x16x32_bf16 v[236:239], v[108:111], v[88:91], v[236:239]
    ds_read_b64 v[88:89], v59 offset:0
    v_pk_max_i16 v194, v194, 0
    v_pk_max_i16 v193, v193, 0
    v_mfma_f32_16x16x32_bf16 v[224:227], v[112:115], v[48:51], v[224:227]
    v_pk_max_i16 v195, v195, 0
    v_cvt_pk_bf16_f32 v200, v200, v201
    v_cvt_pk_bf16_f32 v201, v202, v203
    v_mfma_f32_16x16x32_bf16 v[228:231], v[116:119], v[48:51], v[228:231]
    v_permlane16_swap_b32 v192, v194
    v_permlane16_swap_b32 v193, v195
    v_mfma_f32_16x16x32_bf16 v[232:235], v[120:123], v[48:51], v[232:235]
    buffer_store_dwordx4 v[192:195], v12, s[28:31], s52 offen offset:0 sc1
    v_cvt_pk_bf16_f32 v202, v204, v205
    v_cvt_pk_bf16_f32 v203, v206, v207
    v_mfma_f32_16x16x32_bf16 v[236:239], v[124:127], v[48:51], v[236:239]
    v_pk_max_i16 v200, v200, 0
    v_pk_max_i16 v202, v202, 0
    v_pk_max_i16 v201, v201, 0
    s_waitcnt lgkmcnt(0)
    v_mfma_f32_16x16x16_bf16 v[224:227], v[20:21], v[88:89], v[224:227]
    v_pk_max_i16 v203, v203, 0
    v_mfma_f32_16x16x16_bf16 v[228:231], v[22:23], v[88:89], v[228:231]
    v_permlane16_swap_b32 v200, v202
    v_permlane16_swap_b32 v201, v203
    buffer_store_dwordx4 v[200:203], v12, s[28:31], s52 offen offset:1024 sc1
    v_mfma_f32_16x16x16_bf16 v[232:235], v[24:25], v[88:89], v[232:235]
    v_cvt_pk_bf16_f32 v208, v208, v209
    v_cvt_pk_bf16_f32 v209, v210, v211
    v_mfma_f32_16x16x16_bf16 v[236:239], v[26:27], v[88:89], v[236:239]
    v_cvt_pk_bf16_f32 v210, v212, v213
    v_cvt_pk_bf16_f32 v211, v214, v215
    v_pk_max_i16 v208, v208, 0
    v_mfma_f32_16x16x32_bf16 v[240:243], v[96:99], v[92:95], v[240:243]
    v_pk_max_i16 v210, v210, 0
    v_pk_max_i16 v209, v209, 0
    v_pk_max_i16 v211, v211, 0
    v_mfma_f32_16x16x32_bf16 v[244:247], v[100:103], v[92:95], v[244:247]
    v_cvt_pk_bf16_f32 v216, v216, v217
    v_cvt_pk_bf16_f32 v217, v218, v219
    v_mfma_f32_16x16x32_bf16 v[248:251], v[104:107], v[92:95], v[248:251]
    v_permlane16_swap_b32 v208, v210
    v_permlane16_swap_b32 v209, v211
    buffer_store_dwordx4 v[208:211], v12, s[28:31], s53 offen offset:0 sc1
    v_mfma_f32_16x16x32_bf16 v[252:255], v[108:111], v[92:95], v[252:255]
    ds_read_b64 v[92:93], v59 offset:256
    v_cvt_pk_bf16_f32 v218, v220, v221
    v_cvt_pk_bf16_f32 v219, v222, v223
    v_mfma_f32_16x16x32_bf16 v[240:243], v[112:115], v[52:55], v[240:243]
    v_pk_max_i16 v216, v216, 0
    v_pk_max_i16 v218, v218, 0
    v_pk_max_i16 v217, v217, 0
    v_mfma_f32_16x16x32_bf16 v[244:247], v[116:119], v[52:55], v[244:247]
    v_pk_max_i16 v219, v219, 0
    v_permlane16_swap_b32 v216, v218
    v_mfma_f32_16x16x32_bf16 v[248:251], v[120:123], v[52:55], v[248:251]
    v_permlane16_swap_b32 v217, v219
    buffer_store_dwordx4 v[216:219], v12, s[28:31], s53 offen offset:1024 sc1
    v_mfma_f32_16x16x32_bf16 v[252:255], v[124:127], v[52:55], v[252:255]
    v_cvt_pk_bf16_f32 v224, v224, v225
    v_cvt_pk_bf16_f32 v225, v226, v227
    v_cvt_pk_bf16_f32 v226, v228, v229
    s_waitcnt lgkmcnt(0)
    v_mfma_f32_16x16x16_bf16 v[240:243], v[20:21], v[92:93], v[240:243]
    v_cvt_pk_bf16_f32 v227, v230, v231
    v_pk_max_i16 v224, v224, 0
    v_mfma_f32_16x16x16_bf16 v[244:247], v[22:23], v[92:93], v[244:247]
    v_pk_max_i16 v226, v226, 0
    v_pk_max_i16 v225, v225, 0
    v_pk_max_i16 v227, v227, 0
    v_mfma_f32_16x16x16_bf16 v[248:251], v[24:25], v[92:93], v[248:251]
    v_cvt_pk_bf16_f32 v232, v232, v233
    v_cvt_pk_bf16_f32 v233, v234, v235
    v_permlane16_swap_b32 v224, v226
    v_mfma_f32_16x16x16_bf16 v[252:255], v[26:27], v[92:93], v[252:255]
    v_permlane16_swap_b32 v225, v227
    buffer_store_dwordx4 v[224:227], v12, s[28:31], s54 offen offset:0 sc1
    v_cvt_pk_bf16_f32 v234, v236, v237
    v_cvt_pk_bf16_f32 v235, v238, v239
    v_pk_max_i16 v232, v232, 0
    v_pk_max_i16 v234, v234, 0
    v_pk_max_i16 v233, v233, 0
    v_pk_max_i16 v235, v235, 0
    v_permlane16_swap_b32 v232, v234
    s_nop 0
    v_permlane16_swap_b32 v233, v235
    buffer_store_dwordx4 v[232:235], v12, s[28:31], s54 offen offset:1024 sc1
    v_cvt_pk_bf16_f32 v240, v240, v241
    v_cvt_pk_bf16_f32 v241, v242, v243
    v_cvt_pk_bf16_f32 v242, v244, v245
    v_cvt_pk_bf16_f32 v243, v246, v247
    v_pk_max_i16 v240, v240, 0
    v_pk_max_i16 v242, v242, 0
    v_pk_max_i16 v241, v241, 0
    v_pk_max_i16 v243, v243, 0
    v_cvt_pk_bf16_f32 v248, v248, v249
    v_cvt_pk_bf16_f32 v249, v250, v251
    v_permlane16_swap_b32 v240, v242
    v_permlane16_swap_b32 v241, v243
    buffer_store_dwordx4 v[240:243], v12, s[28:31], s55 offen offset:0 sc1
    v_cvt_pk_bf16_f32 v250, v252, v253
    v_cvt_pk_bf16_f32 v251, v254, v255
    v_pk_max_i16 v248, v248, 0
    v_pk_max_i16 v250, v250, 0
    v_pk_max_i16 v249, v249, 0
    v_pk_max_i16 v251, v251, 0
    v_permlane16_swap_b32 v248, v250
    s_nop 0
    v_permlane16_swap_b32 v249, v251
    buffer_store_dwordx4 v[248:251], v12, s[28:31], s55 offen offset:1024 sc1
    s_endpgm
k1_qk:
    v_lshlrev_b32 v43, 10, v43
    v_lshl_add_u32 v12, v41, 4, v43
    v_mul_u32_u24 v45, 512, v44
    v_add_u32 v12, v12, v45
    v_lshl_add_u32 v14, v44, 4, v41
    v_lshlrev_b32 v14, 2, v14
    s_mul_i32 s36, s44, 4096
    s_xor_b32 s35, s32, 0
    s_lshl2_add_u32 s35, s33, s35
    s_mul_i32 s35, s35, 81920
    s_add_u32 s48, s35, s36
    s_add_u32 s49, s48, 256
    s_xor_b32 s35, s32, 1
    s_lshl2_add_u32 s35, s33, s35
    s_mul_i32 s35, s35, 81920
    s_add_u32 s50, s35, s36
    s_add_u32 s51, s50, 256
    s_xor_b32 s35, s32, 2
    s_lshl2_add_u32 s35, s33, s35
    s_mul_i32 s35, s35, 81920
    s_add_u32 s52, s35, s36
    s_add_u32 s53, s52, 256
    s_xor_b32 s35, s32, 3
    s_lshl2_add_u32 s35, s33, s35
    s_mul_i32 s35, s35, 81920
    s_add_u32 s54, s35, s36
    s_add_u32 s55, s54, 256
    s_mov_b32 s56, 0x00100001
    s_mov_b32 s57, 0x10000100
    s_mov_b32 s58, 0x00200002
    s_mov_b32 s59, 0x20000200
    s_mov_b32 s60, 0x00400004
    s_mov_b32 s61, 0x40000400
    s_mov_b32 s62, 0x00800008
    s_mov_b32 s63, 0x80000800
    s_mov_b32 vcc_lo, -1
    s_mov_b32 vcc_hi, 0
    s_mov_b32 s36, 16384
    s_mov_b32 s37, 32768
    s_mov_b32 s40, -2
    s_mov_b32 s41, 1
.p2align 6
k1_loop_qk:
    s_waitcnt lgkmcnt(4)
    v_mfma_f32_16x16x32_bf16 v[128:131], v[96:99], v[64:67], v[128:131]
    ds_read_b64_tr_b16 v[112:113], v8 offset:16384
    s_add_u32 s40, s40, 1
    v_mfma_f32_16x16x32_bf16 v[132:135], v[100:103], v[64:67], v[132:135]
    ds_read_b64_tr_b16 v[114:115], v8 offset:16896
    s_and_b32 s35, s40, 3
    v_mfma_f32_16x16x32_bf16 v[136:139], v[104:107], v[64:67], v[136:139]
    ds_read_b64_tr_b16 v[116:117], v9 offset:16384
    s_cmp_eq_u32 s35, 3
    v_mfma_f32_16x16x32_bf16 v[140:143], v[108:111], v[64:67], v[140:143]
    ds_read_b64_tr_b16 v[118:119], v9 offset:16896
    s_cselect_b32 s42, 4294918144, s36
    v_mfma_f32_16x16x32_bf16 v[144:147], v[96:99], v[68:71], v[144:147]
    ds_read_b64_tr_b16 v[120:121], v10 offset:16384
    s_add_u32 s41, s41, 1
    v_mfma_f32_16x16x32_bf16 v[148:151], v[100:103], v[68:71], v[148:151]
    ds_read_b64_tr_b16 v[122:123], v10 offset:16896
    s_cmp_eq_u32 s41, 2
    v_mfma_f32_16x16x32_bf16 v[152:155], v[104:107], v[68:71], v[152:155]
    ds_read_b64_tr_b16 v[124:125], v11 offset:16384
    s_cselect_b32 s43, 4294901760, s37
    v_mfma_f32_16x16x32_bf16 v[156:159], v[108:111], v[68:71], v[156:159]
    ds_read_b64_tr_b16 v[126:127], v11 offset:16896
    s_cselect_b32 s41, -1, s41
    v_mfma_f32_16x16x32_bf16 v[32:35], v[64:67], v[64:67], v[32:35]
    v_add_u32 v0, s42, v0
    v_add_u32 v1, s42, v1
    v_mfma_f32_16x16x32_bf16 v[36:39], v[68:71], v[68:71], v[36:39]
    v_add_u32 v2, s42, v2
    v_add_u32 v3, s42, v3
    v_smfmac_f32_16x16x64_bf16 v[28:31], v[16:19], v[64:71], v13
    ds_read_b128 v[64:67], v4 offset:0
    v_add_u32 v8, s43, v8
    v_mfma_f32_16x16x32_bf16 v[160:163], v[96:99], v[72:75], v[160:163]
    ds_read_b128 v[68:71], v4 offset:2048
    v_add_u32 v9, s43, v9
    v_mfma_f32_16x16x32_bf16 v[164:167], v[100:103], v[72:75], v[164:167]
    v_add_u32 v10, s43, v10
    v_add_u32 v11, s43, v11
    v_mfma_f32_16x16x32_bf16 v[168:171], v[104:107], v[72:75], v[168:171]
    v_add_u32 v4, s42, v4
    v_mfma_f32_16x16x32_bf16 v[172:175], v[108:111], v[72:75], v[172:175]
    ds_read_b128 v[72:75], v5 offset:0
    v_smfmac_f32_16x16x64_bf16 v[20:23], v[16:19], v[96:103], v13
    v_mfma_f32_16x16x32_bf16 v[176:179], v[96:99], v[76:79], v[176:179]
    v_mfma_f32_16x16x32_bf16 v[180:183], v[100:103], v[76:79], v[180:183]
    v_mfma_f32_16x16x32_bf16 v[184:187], v[104:107], v[76:79], v[184:187]
    v_mfma_f32_16x16x32_bf16 v[188:191], v[108:111], v[76:79], v[188:191]
    ds_read_b128 v[76:79], v5 offset:2048
    v_add_u32 v5, s42, v5
    v_smfmac_f32_16x16x64_bf16 v[24:27], v[16:19], v[104:111], v13
    s_waitcnt lgkmcnt(3)
    v_mfma_f32_16x16x32_bf16 v[192:195], v[96:99], v[80:83], v[192:195]
    v_mfma_f32_16x16x32_bf16 v[196:199], v[100:103], v[80:83], v[196:199]
    v_mfma_f32_16x16x32_bf16 v[200:203], v[104:107], v[80:83], v[200:203]
    v_mfma_f32_16x16x32_bf16 v[204:207], v[108:111], v[80:83], v[204:207]
    ds_read_b128 v[80:83], v6 offset:0
    v_mfma_f32_16x16x32_bf16 v[208:211], v[96:99], v[84:87], v[208:211]
    v_mfma_f32_16x16x32_bf16 v[212:215], v[100:103], v[84:87], v[212:215]
    v_mfma_f32_16x16x32_bf16 v[216:219], v[104:107], v[84:87], v[216:219]
    v_mfma_f32_16x16x32_bf16 v[220:223], v[108:111], v[84:87], v[220:223]
    ds_read_b128 v[84:87], v6 offset:2048
    v_add_u32 v6, s42, v6
    v_mfma_f32_16x16x32_bf16 v[224:227], v[96:99], v[88:91], v[224:227]
    v_mfma_f32_16x16x32_bf16 v[228:231], v[100:103], v[88:91], v[228:231]
    v_mfma_f32_16x16x32_bf16 v[232:235], v[104:107], v[88:91], v[232:235]
    v_mfma_f32_16x16x32_bf16 v[236:239], v[108:111], v[88:91], v[236:239]
    ds_read_b128 v[88:91], v7 offset:0
    v_mfma_f32_16x16x32_bf16 v[240:243], v[96:99], v[92:95], v[240:243]
    v_mfma_f32_16x16x32_bf16 v[244:247], v[100:103], v[92:95], v[244:247]
    v_mfma_f32_16x16x32_bf16 v[248:251], v[104:107], v[92:95], v[248:251]
    v_mfma_f32_16x16x32_bf16 v[252:255], v[108:111], v[92:95], v[252:255]
    ds_read_b128 v[92:95], v7 offset:2048
    v_add_u32 v7, s42, v7
    v_mfma_f32_16x16x32_bf16 v[128:131], v[112:115], v[64:67], v[128:131]
    v_mfma_f32_16x16x32_bf16 v[132:135], v[116:119], v[64:67], v[132:135]
    v_mfma_f32_16x16x32_bf16 v[136:139], v[120:123], v[64:67], v[136:139]
    v_mfma_f32_16x16x32_bf16 v[140:143], v[124:127], v[64:67], v[140:143]
    s_waitcnt lgkmcnt(4)
    v_mfma_f32_16x16x32_bf16 v[144:147], v[112:115], v[68:71], v[144:147]
    v_mfma_f32_16x16x32_bf16 v[148:151], v[116:119], v[68:71], v[148:151]
    v_mfma_f32_16x16x32_bf16 v[152:155], v[120:123], v[68:71], v[152:155]
    v_mfma_f32_16x16x32_bf16 v[156:159], v[124:127], v[68:71], v[156:159]
    v_mfma_f32_16x16x32_bf16 v[32:35], v[64:67], v[64:67], v[32:35]
    v_mfma_f32_16x16x32_bf16 v[36:39], v[68:71], v[68:71], v[36:39]
    v_smfmac_f32_16x16x64_bf16 v[28:31], v[16:19], v[64:71], v13
    v_mfma_f32_16x16x32_bf16 v[160:163], v[112:115], v[72:75], v[160:163]
    v_mfma_f32_16x16x32_bf16 v[164:167], v[116:119], v[72:75], v[164:167]
    v_mfma_f32_16x16x32_bf16 v[168:171], v[120:123], v[72:75], v[168:171]
    v_mfma_f32_16x16x32_bf16 v[172:175], v[124:127], v[72:75], v[172:175]
    v_smfmac_f32_16x16x64_bf16 v[20:23], v[16:19], v[112:119], v13
    v_mfma_f32_16x16x32_bf16 v[176:179], v[112:115], v[76:79], v[176:179]
    s_barrier
    ds_read_b64_tr_b16 v[96:97], v8 offset:0
    v_mfma_f32_16x16x32_bf16 v[180:183], v[116:119], v[76:79], v[180:183]
    ds_read_b64_tr_b16 v[98:99], v8 offset:512
    v_mfma_f32_16x16x32_bf16 v[184:187], v[120:123], v[76:79], v[184:187]
    ds_read_b128 v[64:67], v0 offset:0
    v_mfma_f32_16x16x32_bf16 v[188:191], v[124:127], v[76:79], v[188:191]
    ds_read_b64_tr_b16 v[100:101], v9 offset:0
    v_smfmac_f32_16x16x64_bf16 v[24:27], v[16:19], v[120:127], v13
    ds_read_b64_tr_b16 v[102:103], v9 offset:512
    s_waitcnt lgkmcnt(5)
    v_mfma_f32_16x16x32_bf16 v[192:195], v[112:115], v[80:83], v[192:195]
    ds_read_b64_tr_b16 v[104:105], v10 offset:0
    v_mfma_f32_16x16x32_bf16 v[196:199], v[116:119], v[80:83], v[196:199]
    ds_read_b64_tr_b16 v[106:107], v10 offset:512
    v_mfma_f32_16x16x32_bf16 v[200:203], v[120:123], v[80:83], v[200:203]
    ds_read_b64_tr_b16 v[108:109], v11 offset:0
    v_mfma_f32_16x16x32_bf16 v[204:207], v[124:127], v[80:83], v[204:207]
    ds_read_b64_tr_b16 v[110:111], v11 offset:512
    v_mfma_f32_16x16x32_bf16 v[208:211], v[112:115], v[84:87], v[208:211]
    ds_read_b128 v[68:71], v0 offset:2048
    v_mfma_f32_16x16x32_bf16 v[212:215], v[116:119], v[84:87], v[212:215]
    ds_read_b128 v[72:75], v1 offset:0
    v_mfma_f32_16x16x32_bf16 v[216:219], v[120:123], v[84:87], v[216:219]
    ds_read_b128 v[76:79], v1 offset:2048
    v_mfma_f32_16x16x32_bf16 v[220:223], v[124:127], v[84:87], v[220:223]
    ds_read_b128 v[80:83], v2 offset:0
    v_mfma_f32_16x16x32_bf16 v[224:227], v[112:115], v[88:91], v[224:227]
    ds_read_b128 v[84:87], v2 offset:2048
    v_mfma_f32_16x16x32_bf16 v[228:231], v[116:119], v[88:91], v[228:231]
    v_mfma_f32_16x16x32_bf16 v[232:235], v[120:123], v[88:91], v[232:235]
    v_mfma_f32_16x16x32_bf16 v[236:239], v[124:127], v[88:91], v[236:239]
    ds_read_b128 v[88:91], v3 offset:0
    v_mfma_f32_16x16x32_bf16 v[240:243], v[112:115], v[92:95], v[240:243]
    v_mfma_f32_16x16x32_bf16 v[244:247], v[116:119], v[92:95], v[244:247]
    v_mfma_f32_16x16x32_bf16 v[248:251], v[120:123], v[92:95], v[248:251]
    v_mfma_f32_16x16x32_bf16 v[252:255], v[124:127], v[92:95], v[252:255]
    ds_read_b128 v[92:95], v3 offset:2048
    s_cmp_lt_i32 s40, 8
    s_cbranch_scc1 k1_loop_qk
    s_waitcnt lgkmcnt(5)
    v_mfma_f32_16x16x32_bf16 v[128:131], v[96:99], v[64:67], v[128:131]
    ds_read_b128 v[40:43], v4 offset:0
    v_mfma_f32_16x16x32_bf16 v[132:135], v[100:103], v[64:67], v[132:135]
    ds_read_b128 v[44:47], v4 offset:2048
    v_mfma_f32_16x16x32_bf16 v[136:139], v[104:107], v[64:67], v[136:139]
    ds_read_b64_tr_b16 v[112:113], v8 offset:16384
    v_mfma_f32_16x16x32_bf16 v[140:143], v[108:111], v[64:67], v[140:143]
    ds_read_b64_tr_b16 v[114:115], v8 offset:16896
    v_mfma_f32_16x16x32_bf16 v[144:147], v[96:99], v[68:71], v[144:147]
    ds_read_b64_tr_b16 v[116:117], v9 offset:16384
    v_mfma_f32_16x16x32_bf16 v[148:151], v[100:103], v[68:71], v[148:151]
    ds_read_b64_tr_b16 v[118:119], v9 offset:16896
    v_mfma_f32_16x16x32_bf16 v[152:155], v[104:107], v[68:71], v[152:155]
    ds_read_b64_tr_b16 v[120:121], v10 offset:16384
    v_mfma_f32_16x16x32_bf16 v[156:159], v[108:111], v[68:71], v[156:159]
    ds_read_b64_tr_b16 v[122:123], v10 offset:16896
    v_mfma_f32_16x16x32_bf16 v[32:35], v[64:67], v[64:67], v[32:35]
    ds_read_b64_tr_b16 v[124:125], v11 offset:16384
    v_mfma_f32_16x16x32_bf16 v[36:39], v[68:71], v[68:71], v[36:39]
    ds_read_b64_tr_b16 v[126:127], v11 offset:16896
    v_smfmac_f32_16x16x64_bf16 v[28:31], v[16:19], v[64:71], v13
    ds_read_b128 v[48:51], v5 offset:0
    v_smfmac_f32_16x16x64_bf16 v[20:23], v[16:19], v[96:103], v13
    ds_read_b128 v[52:55], v5 offset:2048
    v_smfmac_f32_16x16x64_bf16 v[24:27], v[16:19], v[104:111], v13
    v_mfma_f32_16x16x32_bf16 v[160:163], v[96:99], v[72:75], v[160:163]
    v_mfma_f32_16x16x32_bf16 v[164:167], v[100:103], v[72:75], v[164:167]
    v_mfma_f32_16x16x32_bf16 v[168:171], v[104:107], v[72:75], v[168:171]
    v_mfma_f32_16x16x32_bf16 v[172:175], v[108:111], v[72:75], v[172:175]
    s_waitcnt lgkmcnt(2)
    v_mfma_f32_16x16x32_bf16 v[32:35], v[40:43], v[40:43], v[32:35]
    v_mfma_f32_16x16x32_bf16 v[36:39], v[44:47], v[44:47], v[36:39]
    v_smfmac_f32_16x16x64_bf16 v[28:31], v[16:19], v[40:47], v13
    v_smfmac_f32_16x16x64_bf16 v[20:23], v[16:19], v[112:119], v13
    v_smfmac_f32_16x16x64_bf16 v[24:27], v[16:19], v[120:127], v13
    v_mfma_f32_16x16x32_bf16 v[128:131], v[112:115], v[40:43], v[128:131]
    v_mfma_f32_16x16x32_bf16 v[132:135], v[116:119], v[40:43], v[132:135]
    v_mfma_f32_16x16x32_bf16 v[136:139], v[120:123], v[40:43], v[136:139]
    v_mfma_f32_16x16x32_bf16 v[140:143], v[124:127], v[40:43], v[140:143]
    ds_read_b128 v[40:43], v6 offset:0
    v_cndmask_b32 v32, 0, v32, s[56:57]
    v_mfma_f32_16x16x32_bf16 v[144:147], v[112:115], v[44:47], v[144:147]
    v_cndmask_b32 v36, 0, v36, s[56:57]
    v_cndmask_b32 v32, v32, v33, s[58:59]
    v_mfma_f32_16x16x32_bf16 v[148:151], v[116:119], v[44:47], v[148:151]
    v_cndmask_b32 v36, v36, v37, s[58:59]
    v_cndmask_b32 v32, v32, v34, s[60:61]
    v_mfma_f32_16x16x32_bf16 v[152:155], v[120:123], v[44:47], v[152:155]
    v_cndmask_b32 v36, v36, v38, s[60:61]
    v_cndmask_b32 v32, v32, v35, s[62:63]
    v_mfma_f32_16x16x32_bf16 v[156:159], v[124:127], v[44:47], v[156:159]
    ds_read_b128 v[44:47], v6 offset:2048
    v_cndmask_b32 v36, v36, v39, s[62:63]
    v_add_f32 v28, v28, v29
    v_add_f32 v30, v30, v31
    v_permlane32_swap_b32 v32, v36
    v_cndmask_b32 v28, v30, v28, vcc
    v_add_f32 v32, v32, v36
    v_mul_f32 v28, 0xb9cccccd, v28
    v_mov_b32 v36, v32
    v_and_b32 v29, 0xffff0000, v28
    v_sub_f32 v30, v28, v29
    v_permlane16_swap_b32 v32, v36
    v_mul_f32 v28, v28, v28
    v_add_f32 v32, v32, v36
    v_cvt_pk_bf16_f32 v16, v29, v29
    v_mul_f32 v32, 0x3acccccd, v32
    v_fmac_f32 v32, 0xc1800000, v28
    v_max_f32 v32, 0, v32
    v_add_f32 v32, 0x3727c5ac, v32
    v_rsq_f32 v18, v32
    v_cvt_pk_bf16_f32 v17, v30, v30
    v_mul_f32 v18, 0x3f1166db, v18
    ds_write_b128 v15, v[16:19]
    s_waitcnt lgkmcnt(0)
    s_barrier
    s_cmp_lg_u32 s34, 0
    s_cbranch_scc1 k1_qk_nr
    s_add_u32 s24, s16, 23789568
    s_addc_u32 s25, s17, 0
    s_mov_b32 s26, 8192
    s_mov_b32 s27, 0x00020000
    s_lshl2_add_u32 s35, s33, s32
    s_lshl_b32 s35, s35, 7
    buffer_store_dword v18, v14, s[24:27], s35 offen sc1
k1_qk_nr:
    v_mfma_f32_16x16x32_bf16 v[160:163], v[112:115], v[48:51], v[160:163]
    ds_read_b128 v[64:67], v56 offset:0
    v_add_f32 v20, v20, v21
    v_mfma_f32_16x16x32_bf16 v[164:167], v[116:119], v[48:51], v[164:167]
    ds_read_b128 v[68:71], v56 offset:256
    v_add_f32 v22, v22, v23
    v_mfma_f32_16x16x32_bf16 v[168:171], v[120:123], v[48:51], v[168:171]
    ds_read_b128 v[72:75], v57 offset:0
    v_add_f32 v24, v24, v25
    v_mfma_f32_16x16x32_bf16 v[172:175], v[124:127], v[48:51], v[172:175]
    ds_read_b128 v[48:51], v7 offset:0
    v_add_f32 v26, v26, v27
    v_mfma_f32_16x16x32_bf16 v[176:179], v[96:99], v[76:79], v[176:179]
    v_and_b32 v21, 0xffff0000, v20
    v_and_b32 v23, 0xffff0000, v22
    v_mfma_f32_16x16x32_bf16 v[180:183], v[100:103], v[76:79], v[180:183]
    v_and_b32 v25, 0xffff0000, v24
    v_and_b32 v27, 0xffff0000, v26
    v_mfma_f32_16x16x32_bf16 v[184:187], v[104:107], v[76:79], v[184:187]
    v_sub_f32 v20, v20, v21
    v_sub_f32 v22, v22, v23
    v_mfma_f32_16x16x32_bf16 v[188:191], v[108:111], v[76:79], v[188:191]
    ds_read_b128 v[76:79], v57 offset:256
    v_sub_f32 v24, v24, v25
    v_mfma_f32_16x16x32_bf16 v[176:179], v[112:115], v[52:55], v[176:179]
    v_sub_f32 v26, v26, v27
    v_cvt_pk_bf16_f32 v20, v21, v20
    v_mfma_f32_16x16x32_bf16 v[180:183], v[116:119], v[52:55], v[180:183]
    v_cvt_pk_bf16_f32 v22, v23, v22
    v_cvt_pk_bf16_f32 v24, v25, v24
    v_cvt_pk_bf16_f32 v26, v27, v26
    v_mov_b32 v21, v20
    v_mov_b32 v23, v22
    v_mov_b32 v25, v24
    v_mov_b32 v27, v26
    s_waitcnt lgkmcnt(4)
    v_mfma_f32_16x16x16_bf16 v[128:131], v[20:21], v[64:65], v[128:131]
    v_mfma_f32_16x16x16_bf16 v[132:135], v[22:23], v[64:65], v[132:135]
    v_mfma_f32_16x16x16_bf16 v[136:139], v[24:25], v[64:65], v[136:139]
    v_mfma_f32_16x16x16_bf16 v[140:143], v[26:27], v[64:65], v[140:143]
    s_waitcnt lgkmcnt(3)
    v_mfma_f32_16x16x16_bf16 v[144:147], v[20:21], v[68:69], v[144:147]
    v_mfma_f32_16x16x16_bf16 v[148:151], v[22:23], v[68:69], v[148:151]
    v_mfma_f32_16x16x16_bf16 v[152:155], v[24:25], v[68:69], v[152:155]
    v_mfma_f32_16x16x16_bf16 v[156:159], v[26:27], v[68:69], v[156:159]
    v_pk_mul_f32 v[128:129], v[128:129], v[66:67] op_sel_hi:[1,0]
    s_waitcnt lgkmcnt(2)
    v_mfma_f32_16x16x16_bf16 v[160:163], v[20:21], v[72:73], v[160:163]
    v_pk_mul_f32 v[130:131], v[130:131], v[66:67] op_sel_hi:[1,0]
    v_pk_mul_f32 v[132:133], v[132:133], v[66:67] op_sel_hi:[1,0]
    v_mfma_f32_16x16x16_bf16 v[164:167], v[22:23], v[72:73], v[164:167]
    v_pk_mul_f32 v[134:135], v[134:135], v[66:67] op_sel_hi:[1,0]
    v_cvt_pk_bf16_f32 v128, v128, v129
    v_cvt_pk_bf16_f32 v129, v130, v131
    v_mfma_f32_16x16x16_bf16 v[168:171], v[24:25], v[72:73], v[168:171]
    v_cvt_pk_bf16_f32 v130, v132, v133
    v_cvt_pk_bf16_f32 v131, v134, v135
    v_mfma_f32_16x16x16_bf16 v[172:175], v[26:27], v[72:73], v[172:175]
    v_pk_mul_f32 v[136:137], v[136:137], v[66:67] op_sel_hi:[1,0]
    v_pk_mul_f32 v[138:139], v[138:139], v[66:67] op_sel_hi:[1,0]
    v_permlane16_swap_b32 v128, v130
    v_mfma_f32_16x16x32_bf16 v[184:187], v[120:123], v[52:55], v[184:187]
    v_permlane16_swap_b32 v129, v131
    buffer_store_dwordx4 v[128:131], v12, s[28:31], s48 offen offset:0 sc1
    v_mfma_f32_16x16x32_bf16 v[188:191], v[124:127], v[52:55], v[188:191]
    ds_read_b128 v[52:55], v7 offset:2048
    v_pk_mul_f32 v[140:141], v[140:141], v[66:67] op_sel_hi:[1,0]
    v_pk_mul_f32 v[142:143], v[142:143], v[66:67] op_sel_hi:[1,0]
    v_cvt_pk_bf16_f32 v136, v136, v137
    s_waitcnt lgkmcnt(1)
    v_mfma_f32_16x16x16_bf16 v[176:179], v[20:21], v[76:77], v[176:179]
    v_cvt_pk_bf16_f32 v137, v138, v139
    v_cvt_pk_bf16_f32 v138, v140, v141
    v_cvt_pk_bf16_f32 v139, v142, v143
    v_mfma_f32_16x16x16_bf16 v[180:183], v[22:23], v[76:77], v[180:183]
    v_permlane16_swap_b32 v136, v138
    v_mfma_f32_16x16x16_bf16 v[184:187], v[24:25], v[76:77], v[184:187]
    v_permlane16_swap_b32 v137, v139
    buffer_store_dwordx4 v[136:139], v12, s[28:31], s48 offen offset:2048 sc1
    v_pk_mul_f32 v[144:145], v[144:145], v[70:71] op_sel_hi:[1,0]
    v_mfma_f32_16x16x16_bf16 v[188:191], v[26:27], v[76:77], v[188:191]
    v_pk_mul_f32 v[146:147], v[146:147], v[70:71] op_sel_hi:[1,0]
    v_pk_mul_f32 v[148:149], v[148:149], v[70:71] op_sel_hi:[1,0]
    v_mfma_f32_16x16x32_bf16 v[192:195], v[96:99], v[80:83], v[192:195]
    v_pk_mul_f32 v[150:151], v[150:151], v[70:71] op_sel_hi:[1,0]
    v_cvt_pk_bf16_f32 v144, v144, v145
    v_cvt_pk_bf16_f32 v145, v146, v147
    v_mfma_f32_16x16x32_bf16 v[196:199], v[100:103], v[80:83], v[196:199]
    v_cvt_pk_bf16_f32 v146, v148, v149
    v_cvt_pk_bf16_f32 v147, v150, v151
    v_pk_mul_f32 v[152:153], v[152:153], v[70:71] op_sel_hi:[1,0]
    v_mfma_f32_16x16x32_bf16 v[200:203], v[104:107], v[80:83], v[200:203]
    v_pk_mul_f32 v[154:155], v[154:155], v[70:71] op_sel_hi:[1,0]
    v_permlane16_swap_b32 v144, v146
    v_mfma_f32_16x16x32_bf16 v[204:207], v[108:111], v[80:83], v[204:207]
    ds_read_b128 v[80:83], v58 offset:0
    v_permlane16_swap_b32 v145, v147
    buffer_store_dwordx4 v[144:147], v12, s[28:31], s49 offen offset:0 sc1
    v_pk_mul_f32 v[156:157], v[156:157], v[70:71] op_sel_hi:[1,0]
    v_mfma_f32_16x16x32_bf16 v[192:195], v[112:115], v[40:43], v[192:195]
    v_pk_mul_f32 v[158:159], v[158:159], v[70:71] op_sel_hi:[1,0]
    v_cvt_pk_bf16_f32 v152, v152, v153
    v_mfma_f32_16x16x32_bf16 v[196:199], v[116:119], v[40:43], v[196:199]
    v_cvt_pk_bf16_f32 v153, v154, v155
    v_cvt_pk_bf16_f32 v154, v156, v157
    v_cvt_pk_bf16_f32 v155, v158, v159
    v_mfma_f32_16x16x32_bf16 v[200:203], v[120:123], v[40:43], v[200:203]
    v_permlane16_swap_b32 v152, v154
    v_permlane16_swap_b32 v153, v155
    v_mfma_f32_16x16x32_bf16 v[204:207], v[124:127], v[40:43], v[204:207]
    buffer_store_dwordx4 v[152:155], v12, s[28:31], s49 offen offset:2048 sc1
    v_pk_mul_f32 v[160:161], v[160:161], v[74:75] op_sel_hi:[1,0]
    s_waitcnt lgkmcnt(0)
    v_mfma_f32_16x16x16_bf16 v[192:195], v[20:21], v[80:81], v[192:195]
    v_pk_mul_f32 v[162:163], v[162:163], v[74:75] op_sel_hi:[1,0]
    v_pk_mul_f32 v[164:165], v[164:165], v[74:75] op_sel_hi:[1,0]
    v_pk_mul_f32 v[166:167], v[166:167], v[74:75] op_sel_hi:[1,0]
    v_mfma_f32_16x16x16_bf16 v[196:199], v[22:23], v[80:81], v[196:199]
    v_cvt_pk_bf16_f32 v160, v160, v161
    v_cvt_pk_bf16_f32 v161, v162, v163
    v_mfma_f32_16x16x16_bf16 v[200:203], v[24:25], v[80:81], v[200:203]
    v_cvt_pk_bf16_f32 v162, v164, v165
    v_cvt_pk_bf16_f32 v163, v166, v167
    v_pk_mul_f32 v[168:169], v[168:169], v[74:75] op_sel_hi:[1,0]
    v_mfma_f32_16x16x16_bf16 v[204:207], v[26:27], v[80:81], v[204:207]
    v_pk_mul_f32 v[170:171], v[170:171], v[74:75] op_sel_hi:[1,0]
    v_permlane16_swap_b32 v160, v162
    v_permlane16_swap_b32 v161, v163
    v_mfma_f32_16x16x32_bf16 v[208:211], v[96:99], v[84:87], v[208:211]
    buffer_store_dwordx4 v[160:163], v12, s[28:31], s50 offen offset:0 sc1
    v_pk_mul_f32 v[172:173], v[172:173], v[74:75] op_sel_hi:[1,0]
    v_mfma_f32_16x16x32_bf16 v[212:215], v[100:103], v[84:87], v[212:215]
    v_pk_mul_f32 v[174:175], v[174:175], v[74:75] op_sel_hi:[1,0]
    v_cvt_pk_bf16_f32 v168, v168, v169
    v_cvt_pk_bf16_f32 v169, v170, v171
    v_mfma_f32_16x16x32_bf16 v[216:219], v[104:107], v[84:87], v[216:219]
    v_cvt_pk_bf16_f32 v170, v172, v173
    v_cvt_pk_bf16_f32 v171, v174, v175
    v_mfma_f32_16x16x32_bf16 v[220:223], v[108:111], v[84:87], v[220:223]
    ds_read_b128 v[84:87], v58 offset:256
    v_permlane16_swap_b32 v168, v170
    v_permlane16_swap_b32 v169, v171
    v_mfma_f32_16x16x32_bf16 v[208:211], v[112:115], v[44:47], v[208:211]
    buffer_store_dwordx4 v[168:171], v12, s[28:31], s50 offen offset:2048 sc1
    v_pk_mul_f32 v[176:177], v[176:177], v[78:79] op_sel_hi:[1,0]
    v_pk_mul_f32 v[178:179], v[178:179], v[78:79] op_sel_hi:[1,0]
    v_mfma_f32_16x16x32_bf16 v[212:215], v[116:119], v[44:47], v[212:215]
    v_pk_mul_f32 v[180:181], v[180:181], v[78:79] op_sel_hi:[1,0]
    v_pk_mul_f32 v[182:183], v[182:183], v[78:79] op_sel_hi:[1,0]
    v_mfma_f32_16x16x32_bf16 v[216:219], v[120:123], v[44:47], v[216:219]
    v_cvt_pk_bf16_f32 v176, v176, v177
    v_cvt_pk_bf16_f32 v177, v178, v179
    v_cvt_pk_bf16_f32 v178, v180, v181
    v_mfma_f32_16x16x32_bf16 v[220:223], v[124:127], v[44:47], v[220:223]
    v_cvt_pk_bf16_f32 v179, v182, v183
    v_pk_mul_f32 v[184:185], v[184:185], v[78:79] op_sel_hi:[1,0]
    s_waitcnt lgkmcnt(0)
    v_mfma_f32_16x16x16_bf16 v[208:211], v[20:21], v[84:85], v[208:211]
    v_pk_mul_f32 v[186:187], v[186:187], v[78:79] op_sel_hi:[1,0]
    v_permlane16_swap_b32 v176, v178
    v_permlane16_swap_b32 v177, v179
    v_mfma_f32_16x16x16_bf16 v[212:215], v[22:23], v[84:85], v[212:215]
    buffer_store_dwordx4 v[176:179], v12, s[28:31], s51 offen offset:0 sc1
    v_pk_mul_f32 v[188:189], v[188:189], v[78:79] op_sel_hi:[1,0]
    v_pk_mul_f32 v[190:191], v[190:191], v[78:79] op_sel_hi:[1,0]
    v_mfma_f32_16x16x16_bf16 v[216:219], v[24:25], v[84:85], v[216:219]
    v_cvt_pk_bf16_f32 v184, v184, v185
    v_cvt_pk_bf16_f32 v185, v186, v187
    v_mfma_f32_16x16x16_bf16 v[220:223], v[26:27], v[84:85], v[220:223]
    v_cvt_pk_bf16_f32 v186, v188, v189
    v_cvt_pk_bf16_f32 v187, v190, v191
    v_mfma_f32_16x16x32_bf16 v[224:227], v[96:99], v[88:91], v[224:227]
    v_permlane16_swap_b32 v184, v186
    v_permlane16_swap_b32 v185, v187
    v_mfma_f32_16x16x32_bf16 v[228:231], v[100:103], v[88:91], v[228:231]
    buffer_store_dwordx4 v[184:187], v12, s[28:31], s51 offen offset:2048 sc1
    v_pk_mul_f32 v[192:193], v[192:193], v[82:83] op_sel_hi:[1,0]
    v_pk_mul_f32 v[194:195], v[194:195], v[82:83] op_sel_hi:[1,0]
    v_mfma_f32_16x16x32_bf16 v[232:235], v[104:107], v[88:91], v[232:235]
    v_pk_mul_f32 v[196:197], v[196:197], v[82:83] op_sel_hi:[1,0]
    v_pk_mul_f32 v[198:199], v[198:199], v[82:83] op_sel_hi:[1,0]
    v_cvt_pk_bf16_f32 v192, v192, v193
    v_mfma_f32_16x16x32_bf16 v[236:239], v[108:111], v[88:91], v[236:239]
    ds_read_b128 v[88:91], v59 offset:0
    v_cvt_pk_bf16_f32 v193, v194, v195
    v_cvt_pk_bf16_f32 v194, v196, v197
    v_mfma_f32_16x16x32_bf16 v[224:227], v[112:115], v[48:51], v[224:227]
    v_cvt_pk_bf16_f32 v195, v198, v199
    v_pk_mul_f32 v[200:201], v[200:201], v[82:83] op_sel_hi:[1,0]
    v_pk_mul_f32 v[202:203], v[202:203], v[82:83] op_sel_hi:[1,0]
    v_mfma_f32_16x16x32_bf16 v[228:231], v[116:119], v[48:51], v[228:231]
    v_permlane16_swap_b32 v192, v194
    v_permlane16_swap_b32 v193, v195
    v_mfma_f32_16x16x32_bf16 v[232:235], v[120:123], v[48:51], v[232:235]
    buffer_store_dwordx4 v[192:195], v12, s[28:31], s52 offen offset:0 sc1
    v_pk_mul_f32 v[204:205], v[204:205], v[82:83] op_sel_hi:[1,0]
    v_pk_mul_f32 v[206:207], v[206:207], v[82:83] op_sel_hi:[1,0]
    v_mfma_f32_16x16x32_bf16 v[236:239], v[124:127], v[48:51], v[236:239]
    v_cvt_pk_bf16_f32 v200, v200, v201
    v_cvt_pk_bf16_f32 v201, v202, v203
    v_cvt_pk_bf16_f32 v202, v204, v205
    s_waitcnt lgkmcnt(0)
    v_mfma_f32_16x16x16_bf16 v[224:227], v[20:21], v[88:89], v[224:227]
    v_cvt_pk_bf16_f32 v203, v206, v207
    v_mfma_f32_16x16x16_bf16 v[228:231], v[22:23], v[88:89], v[228:231]
    v_permlane16_swap_b32 v200, v202
    v_permlane16_swap_b32 v201, v203
    buffer_store_dwordx4 v[200:203], v12, s[28:31], s52 offen offset:2048 sc1
    v_mfma_f32_16x16x16_bf16 v[232:235], v[24:25], v[88:89], v[232:235]
    v_pk_mul_f32 v[208:209], v[208:209], v[86:87] op_sel_hi:[1,0]
    v_pk_mul_f32 v[210:211], v[210:211], v[86:87] op_sel_hi:[1,0]
    v_mfma_f32_16x16x16_bf16 v[236:239], v[26:27], v[88:89], v[236:239]
    v_pk_mul_f32 v[212:213], v[212:213], v[86:87] op_sel_hi:[1,0]
    v_pk_mul_f32 v[214:215], v[214:215], v[86:87] op_sel_hi:[1,0]
    v_cvt_pk_bf16_f32 v208, v208, v209
    v_mfma_f32_16x16x32_bf16 v[240:243], v[96:99], v[92:95], v[240:243]
    v_cvt_pk_bf16_f32 v209, v210, v211
    v_cvt_pk_bf16_f32 v210, v212, v213
    v_cvt_pk_bf16_f32 v211, v214, v215
    v_mfma_f32_16x16x32_bf16 v[244:247], v[100:103], v[92:95], v[244:247]
    v_pk_mul_f32 v[216:217], v[216:217], v[86:87] op_sel_hi:[1,0]
    v_pk_mul_f32 v[218:219], v[218:219], v[86:87] op_sel_hi:[1,0]
    v_mfma_f32_16x16x32_bf16 v[248:251], v[104:107], v[92:95], v[248:251]
    v_permlane16_swap_b32 v208, v210
    v_permlane16_swap_b32 v209, v211
    buffer_store_dwordx4 v[208:211], v12, s[28:31], s53 offen offset:0 sc1
    v_mfma_f32_16x16x32_bf16 v[252:255], v[108:111], v[92:95], v[252:255]
    ds_read_b128 v[92:95], v59 offset:256
    v_pk_mul_f32 v[220:221], v[220:221], v[86:87] op_sel_hi:[1,0]
    v_pk_mul_f32 v[222:223], v[222:223], v[86:87] op_sel_hi:[1,0]
    v_mfma_f32_16x16x32_bf16 v[240:243], v[112:115], v[52:55], v[240:243]
    v_cvt_pk_bf16_f32 v216, v216, v217
    v_cvt_pk_bf16_f32 v217, v218, v219
    v_cvt_pk_bf16_f32 v218, v220, v221
    v_mfma_f32_16x16x32_bf16 v[244:247], v[116:119], v[52:55], v[244:247]
    v_cvt_pk_bf16_f32 v219, v222, v223
    v_permlane16_swap_b32 v216, v218
    v_mfma_f32_16x16x32_bf16 v[248:251], v[120:123], v[52:55], v[248:251]
    v_permlane16_swap_b32 v217, v219
    buffer_store_dwordx4 v[216:219], v12, s[28:31], s53 offen offset:2048 sc1
    v_mfma_f32_16x16x32_bf16 v[252:255], v[124:127], v[52:55], v[252:255]
    v_pk_mul_f32 v[224:225], v[224:225], v[90:91] op_sel_hi:[1,0]
    v_pk_mul_f32 v[226:227], v[226:227], v[90:91] op_sel_hi:[1,0]
    v_pk_mul_f32 v[228:229], v[228:229], v[90:91] op_sel_hi:[1,0]
    s_waitcnt lgkmcnt(0)
    v_mfma_f32_16x16x16_bf16 v[240:243], v[20:21], v[92:93], v[240:243]
    v_pk_mul_f32 v[230:231], v[230:231], v[90:91] op_sel_hi:[1,0]
    v_cvt_pk_bf16_f32 v224, v224, v225
    v_mfma_f32_16x16x16_bf16 v[244:247], v[22:23], v[92:93], v[244:247]
    v_cvt_pk_bf16_f32 v225, v226, v227
    v_cvt_pk_bf16_f32 v226, v228, v229
    v_cvt_pk_bf16_f32 v227, v230, v231
    v_mfma_f32_16x16x16_bf16 v[248:251], v[24:25], v[92:93], v[248:251]
    v_pk_mul_f32 v[232:233], v[232:233], v[90:91] op_sel_hi:[1,0]
    v_pk_mul_f32 v[234:235], v[234:235], v[90:91] op_sel_hi:[1,0]
    v_permlane16_swap_b32 v224, v226
    v_mfma_f32_16x16x16_bf16 v[252:255], v[26:27], v[92:93], v[252:255]
    v_permlane16_swap_b32 v225, v227
    buffer_store_dwordx4 v[224:227], v12, s[28:31], s54 offen offset:0 sc1
    v_pk_mul_f32 v[236:237], v[236:237], v[90:91] op_sel_hi:[1,0]
    v_pk_mul_f32 v[238:239], v[238:239], v[90:91] op_sel_hi:[1,0]
    v_cvt_pk_bf16_f32 v232, v232, v233
    v_cvt_pk_bf16_f32 v233, v234, v235
    v_cvt_pk_bf16_f32 v234, v236, v237
    v_cvt_pk_bf16_f32 v235, v238, v239
    s_nop 0
    v_permlane16_swap_b32 v232, v234
    v_permlane16_swap_b32 v233, v235
    buffer_store_dwordx4 v[232:235], v12, s[28:31], s54 offen offset:2048 sc1
    v_pk_mul_f32 v[240:241], v[240:241], v[94:95] op_sel_hi:[1,0]
    v_pk_mul_f32 v[242:243], v[242:243], v[94:95] op_sel_hi:[1,0]
    v_pk_mul_f32 v[244:245], v[244:245], v[94:95] op_sel_hi:[1,0]
    v_pk_mul_f32 v[246:247], v[246:247], v[94:95] op_sel_hi:[1,0]
    v_cvt_pk_bf16_f32 v240, v240, v241
    v_cvt_pk_bf16_f32 v241, v242, v243
    v_cvt_pk_bf16_f32 v242, v244, v245
    v_cvt_pk_bf16_f32 v243, v246, v247
    v_pk_mul_f32 v[248:249], v[248:249], v[94:95] op_sel_hi:[1,0]
    v_pk_mul_f32 v[250:251], v[250:251], v[94:95] op_sel_hi:[1,0]
    v_permlane16_swap_b32 v240, v242
    v_permlane16_swap_b32 v241, v243
    buffer_store_dwordx4 v[240:243], v12, s[28:31], s55 offen offset:0 sc1
    v_pk_mul_f32 v[252:253], v[252:253], v[94:95] op_sel_hi:[1,0]
    v_pk_mul_f32 v[254:255], v[254:255], v[94:95] op_sel_hi:[1,0]
    v_cvt_pk_bf16_f32 v248, v248, v249
    v_cvt_pk_bf16_f32 v249, v250, v251
    v_cvt_pk_bf16_f32 v250, v252, v253
    v_cvt_pk_bf16_f32 v251, v254, v255
    s_nop 0
    v_permlane16_swap_b32 v248, v250
    v_permlane16_swap_b32 v249, v251
    buffer_store_dwordx4 v[248:251], v12, s[28:31], s55 offen offset:2048 sc1
    s_endpgm
k1_v:
    s_cmp_lt_u32 s44, 58
    s_cselect_b32 s30, s30, 0
    v_lshlrev_b32 v43, 8, v43
    v_lshl_add_u32 v12, v41, 4, v43
    v_mul_u32_u24 v45, 10240, v44
    v_add_u32 v12, v12, v45
    s_lshl_b32 s35, s32, 7
    s_add_u32 s35, s35, 51200
    v_lshl_add_u32 v14, v40, 4, s35
    v_lshl_add_u32 v62, v44, 4, v41
    v_lshl_add_u32 v62, v62, 2, s35
    s_mul_i32 s36, s44, 1024
    s_add_u32 s36, s36, 5193728
    s_xor_b32 s35, s32, 0
    s_lshl2_add_u32 s35, s33, s35
    s_mul_i32 s35, s35, 40960
    s_add_u32 s48, s35, s36
    s_add_u32 s49, s48, 20480
    s_xor_b32 s35, s32, 1
    s_lshl2_add_u32 s35, s33, s35
    s_mul_i32 s35, s35, 40960
    s_add_u32 s50, s35, s36
    s_add_u32 s51, s50, 20480
    s_xor_b32 s35, s32, 2
    s_lshl2_add_u32 s35, s33, s35
    s_mul_i32 s35, s35, 40960
    s_add_u32 s52, s35, s36
    s_add_u32 s53, s52, 20480
    s_xor_b32 s35, s32, 3
    s_lshl2_add_u32 s35, s33, s35
    s_mul_i32 s35, s35, 40960
    s_add_u32 s54, s35, s36
    s_add_u32 s55, s54, 20480
    s_mov_b32 s56, 0x00100001
    s_mov_b32 s57, 0x10000100
    s_mov_b32 s58, 0x00200002
    s_mov_b32 s59, 0x20000200
    s_mov_b32 s60, 0x00400004
    s_mov_b32 s61, 0x40000400
    s_mov_b32 s62, 0x00800008
    s_mov_b32 s63, 0x80000800
    s_mov_b32 vcc_lo, -1
    s_mov_b32 vcc_hi, 0
    s_mov_b32 s36, 16384
    s_mov_b32 s37, 32768
    s_mov_b32 s40, -2
    s_mov_b32 s41, 1
.p2align 6
k1_loop_v:
    s_waitcnt lgkmcnt(4)
    v_mfma_f32_16x16x32_bf16 v[128:131], v[64:67], v[96:99], v[128:131]
    ds_read_b64_tr_b16 v[112:113], v8 offset:16384
    s_add_u32 s40, s40, 1
    v_mfma_f32_16x16x32_bf16 v[132:135], v[64:67], v[100:103], v[132:135]
    ds_read_b64_tr_b16 v[114:115], v8 offset:16896
    s_and_b32 s35, s40, 3
    v_mfma_f32_16x16x32_bf16 v[136:139], v[64:67], v[104:107], v[136:139]
    ds_read_b64_tr_b16 v[116:117], v9 offset:16384
    s_cmp_eq_u32 s35, 3
    v_mfma_f32_16x16x32_bf16 v[140:143], v[64:67], v[108:111], v[140:143]
    ds_read_b64_tr_b16 v[118:119], v9 offset:16896
    s_cselect_b32 s42, 4294918144, s36
    v_mfma_f32_16x16x32_bf16 v[144:147], v[68:71], v[96:99], v[144:147]
    ds_read_b64_tr_b16 v[120:121], v10 offset:16384
    s_add_u32 s41, s41, 1
    v_mfma_f32_16x16x32_bf16 v[148:151], v[68:71], v[100:103], v[148:151]
    ds_read_b64_tr_b16 v[122:123], v10 offset:16896
    s_cmp_eq_u32 s41, 2
    v_mfma_f32_16x16x32_bf16 v[152:155], v[68:71], v[104:107], v[152:155]
    ds_read_b64_tr_b16 v[124:125], v11 offset:16384
    s_cselect_b32 s43, 4294901760, s37
    v_mfma_f32_16x16x32_bf16 v[156:159], v[68:71], v[108:111], v[156:159]
    ds_read_b64_tr_b16 v[126:127], v11 offset:16896
    s_cselect_b32 s41, -1, s41
    v_mfma_f32_16x16x32_bf16 v[32:35], v[64:67], v[64:67], v[32:35]
    v_add_u32 v0, s42, v0
    v_add_u32 v1, s42, v1
    v_mfma_f32_16x16x32_bf16 v[36:39], v[68:71], v[68:71], v[36:39]
    v_add_u32 v2, s42, v2
    v_add_u32 v3, s42, v3
    v_smfmac_f32_16x16x64_bf16 v[28:31], v[16:19], v[64:71], v13
    ds_read_b128 v[64:67], v4 offset:0
    v_add_u32 v8, s43, v8
    v_mfma_f32_16x16x32_bf16 v[160:163], v[72:75], v[96:99], v[160:163]
    ds_read_b128 v[68:71], v4 offset:2048
    v_add_u32 v9, s43, v9
    v_mfma_f32_16x16x32_bf16 v[164:167], v[72:75], v[100:103], v[164:167]
    v_add_u32 v10, s43, v10
    v_add_u32 v11, s43, v11
    v_mfma_f32_16x16x32_bf16 v[168:171], v[72:75], v[104:107], v[168:171]
    v_add_u32 v4, s42, v4
    v_mfma_f32_16x16x32_bf16 v[172:175], v[72:75], v[108:111], v[172:175]
    ds_read_b128 v[72:75], v5 offset:0
    v_smfmac_f32_16x16x64_bf16 v[20:23], v[16:19], v[96:103], v13
    v_mfma_f32_16x16x32_bf16 v[176:179], v[76:79], v[96:99], v[176:179]
    v_mfma_f32_16x16x32_bf16 v[180:183], v[76:79], v[100:103], v[180:183]
    v_mfma_f32_16x16x32_bf16 v[184:187], v[76:79], v[104:107], v[184:187]
    v_mfma_f32_16x16x32_bf16 v[188:191], v[76:79], v[108:111], v[188:191]
    ds_read_b128 v[76:79], v5 offset:2048
    v_add_u32 v5, s42, v5
    v_smfmac_f32_16x16x64_bf16 v[24:27], v[16:19], v[104:111], v13
    s_waitcnt lgkmcnt(3)
    v_mfma_f32_16x16x32_bf16 v[192:195], v[80:83], v[96:99], v[192:195]
    v_mfma_f32_16x16x32_bf16 v[196:199], v[80:83], v[100:103], v[196:199]
    v_mfma_f32_16x16x32_bf16 v[200:203], v[80:83], v[104:107], v[200:203]
    v_mfma_f32_16x16x32_bf16 v[204:207], v[80:83], v[108:111], v[204:207]
    ds_read_b128 v[80:83], v6 offset:0
    v_mfma_f32_16x16x32_bf16 v[208:211], v[84:87], v[96:99], v[208:211]
    v_mfma_f32_16x16x32_bf16 v[212:215], v[84:87], v[100:103], v[212:215]
    v_mfma_f32_16x16x32_bf16 v[216:219], v[84:87], v[104:107], v[216:219]
    v_mfma_f32_16x16x32_bf16 v[220:223], v[84:87], v[108:111], v[220:223]
    ds_read_b128 v[84:87], v6 offset:2048
    v_add_u32 v6, s42, v6
    v_mfma_f32_16x16x32_bf16 v[224:227], v[88:91], v[96:99], v[224:227]
    v_mfma_f32_16x16x32_bf16 v[228:231], v[88:91], v[100:103], v[228:231]
    v_mfma_f32_16x16x32_bf16 v[232:235], v[88:91], v[104:107], v[232:235]
    v_mfma_f32_16x16x32_bf16 v[236:239], v[88:91], v[108:111], v[236:239]
    ds_read_b128 v[88:91], v7 offset:0
    v_mfma_f32_16x16x32_bf16 v[240:243], v[92:95], v[96:99], v[240:243]
    v_mfma_f32_16x16x32_bf16 v[244:247], v[92:95], v[100:103], v[244:247]
    v_mfma_f32_16x16x32_bf16 v[248:251], v[92:95], v[104:107], v[248:251]
    v_mfma_f32_16x16x32_bf16 v[252:255], v[92:95], v[108:111], v[252:255]
    ds_read_b128 v[92:95], v7 offset:2048
    v_add_u32 v7, s42, v7
    v_mfma_f32_16x16x32_bf16 v[128:131], v[64:67], v[112:115], v[128:131]
    v_mfma_f32_16x16x32_bf16 v[132:135], v[64:67], v[116:119], v[132:135]
    v_mfma_f32_16x16x32_bf16 v[136:139], v[64:67], v[120:123], v[136:139]
    v_mfma_f32_16x16x32_bf16 v[140:143], v[64:67], v[124:127], v[140:143]
    s_waitcnt lgkmcnt(4)
    v_mfma_f32_16x16x32_bf16 v[144:147], v[68:71], v[112:115], v[144:147]
    v_mfma_f32_16x16x32_bf16 v[148:151], v[68:71], v[116:119], v[148:151]
    v_mfma_f32_16x16x32_bf16 v[152:155], v[68:71], v[120:123], v[152:155]
    v_mfma_f32_16x16x32_bf16 v[156:159], v[68:71], v[124:127], v[156:159]
    v_mfma_f32_16x16x32_bf16 v[32:35], v[64:67], v[64:67], v[32:35]
    v_mfma_f32_16x16x32_bf16 v[36:39], v[68:71], v[68:71], v[36:39]
    v_smfmac_f32_16x16x64_bf16 v[28:31], v[16:19], v[64:71], v13
    v_mfma_f32_16x16x32_bf16 v[160:163], v[72:75], v[112:115], v[160:163]
    v_mfma_f32_16x16x32_bf16 v[164:167], v[72:75], v[116:119], v[164:167]
    v_mfma_f32_16x16x32_bf16 v[168:171], v[72:75], v[120:123], v[168:171]
    v_mfma_f32_16x16x32_bf16 v[172:175], v[72:75], v[124:127], v[172:175]
    v_smfmac_f32_16x16x64_bf16 v[20:23], v[16:19], v[112:119], v13
    v_mfma_f32_16x16x32_bf16 v[176:179], v[76:79], v[112:115], v[176:179]
    s_barrier
    ds_read_b64_tr_b16 v[96:97], v8 offset:0
    v_mfma_f32_16x16x32_bf16 v[180:183], v[76:79], v[116:119], v[180:183]
    ds_read_b64_tr_b16 v[98:99], v8 offset:512
    v_mfma_f32_16x16x32_bf16 v[184:187], v[76:79], v[120:123], v[184:187]
    ds_read_b128 v[64:67], v0 offset:0
    v_mfma_f32_16x16x32_bf16 v[188:191], v[76:79], v[124:127], v[188:191]
    ds_read_b64_tr_b16 v[100:101], v9 offset:0
    v_smfmac_f32_16x16x64_bf16 v[24:27], v[16:19], v[120:127], v13
    ds_read_b64_tr_b16 v[102:103], v9 offset:512
    s_waitcnt lgkmcnt(5)
    v_mfma_f32_16x16x32_bf16 v[192:195], v[80:83], v[112:115], v[192:195]
    ds_read_b64_tr_b16 v[104:105], v10 offset:0
    v_mfma_f32_16x16x32_bf16 v[196:199], v[80:83], v[116:119], v[196:199]
    ds_read_b64_tr_b16 v[106:107], v10 offset:512
    v_mfma_f32_16x16x32_bf16 v[200:203], v[80:83], v[120:123], v[200:203]
    ds_read_b64_tr_b16 v[108:109], v11 offset:0
    v_mfma_f32_16x16x32_bf16 v[204:207], v[80:83], v[124:127], v[204:207]
    ds_read_b64_tr_b16 v[110:111], v11 offset:512
    v_mfma_f32_16x16x32_bf16 v[208:211], v[84:87], v[112:115], v[208:211]
    ds_read_b128 v[68:71], v0 offset:2048
    v_mfma_f32_16x16x32_bf16 v[212:215], v[84:87], v[116:119], v[212:215]
    ds_read_b128 v[72:75], v1 offset:0
    v_mfma_f32_16x16x32_bf16 v[216:219], v[84:87], v[120:123], v[216:219]
    ds_read_b128 v[76:79], v1 offset:2048
    v_mfma_f32_16x16x32_bf16 v[220:223], v[84:87], v[124:127], v[220:223]
    ds_read_b128 v[80:83], v2 offset:0
    v_mfma_f32_16x16x32_bf16 v[224:227], v[88:91], v[112:115], v[224:227]
    ds_read_b128 v[84:87], v2 offset:2048
    v_mfma_f32_16x16x32_bf16 v[228:231], v[88:91], v[116:119], v[228:231]
    v_mfma_f32_16x16x32_bf16 v[232:235], v[88:91], v[120:123], v[232:235]
    v_mfma_f32_16x16x32_bf16 v[236:239], v[88:91], v[124:127], v[236:239]
    ds_read_b128 v[88:91], v3 offset:0
    v_mfma_f32_16x16x32_bf16 v[240:243], v[92:95], v[112:115], v[240:243]
    v_mfma_f32_16x16x32_bf16 v[244:247], v[92:95], v[116:119], v[244:247]
    v_mfma_f32_16x16x32_bf16 v[248:251], v[92:95], v[120:123], v[248:251]
    v_mfma_f32_16x16x32_bf16 v[252:255], v[92:95], v[124:127], v[252:255]
    ds_read_b128 v[92:95], v3 offset:2048
    s_cmp_lt_i32 s40, 8
    s_cbranch_scc1 k1_loop_v
    s_waitcnt lgkmcnt(5)
    v_mfma_f32_16x16x32_bf16 v[128:131], v[64:67], v[96:99], v[128:131]
    ds_read_b128 v[40:43], v4 offset:0
    v_mfma_f32_16x16x32_bf16 v[132:135], v[64:67], v[100:103], v[132:135]
    ds_read_b128 v[44:47], v4 offset:2048
    v_mfma_f32_16x16x32_bf16 v[136:139], v[64:67], v[104:107], v[136:139]
    ds_read_b64_tr_b16 v[112:113], v8 offset:16384
    v_mfma_f32_16x16x32_bf16 v[140:143], v[64:67], v[108:111], v[140:143]
    ds_read_b64_tr_b16 v[114:115], v8 offset:16896
    v_mfma_f32_16x16x32_bf16 v[144:147], v[68:71], v[96:99], v[144:147]
    ds_read_b64_tr_b16 v[116:117], v9 offset:16384
    v_mfma_f32_16x16x32_bf16 v[148:151], v[68:71], v[100:103], v[148:151]
    ds_read_b64_tr_b16 v[118:119], v9 offset:16896
    v_mfma_f32_16x16x32_bf16 v[152:155], v[68:71], v[104:107], v[152:155]
    ds_read_b64_tr_b16 v[120:121], v10 offset:16384
    v_mfma_f32_16x16x32_bf16 v[156:159], v[68:71], v[108:111], v[156:159]
    ds_read_b64_tr_b16 v[122:123], v10 offset:16896
    v_mfma_f32_16x16x32_bf16 v[32:35], v[64:67], v[64:67], v[32:35]
    ds_read_b64_tr_b16 v[124:125], v11 offset:16384
    v_mfma_f32_16x16x32_bf16 v[36:39], v[68:71], v[68:71], v[36:39]
    ds_read_b64_tr_b16 v[126:127], v11 offset:16896
    v_smfmac_f32_16x16x64_bf16 v[28:31], v[16:19], v[64:71], v13
    ds_read_b128 v[48:51], v5 offset:0
    v_smfmac_f32_16x16x64_bf16 v[20:23], v[16:19], v[96:103], v13
    ds_read_b128 v[52:55], v5 offset:2048
    v_smfmac_f32_16x16x64_bf16 v[24:27], v[16:19], v[104:111], v13
    v_mfma_f32_16x16x32_bf16 v[160:163], v[72:75], v[96:99], v[160:163]
    v_mfma_f32_16x16x32_bf16 v[164:167], v[72:75], v[100:103], v[164:167]
    v_mfma_f32_16x16x32_bf16 v[168:171], v[72:75], v[104:107], v[168:171]
    v_mfma_f32_16x16x32_bf16 v[172:175], v[72:75], v[108:111], v[172:175]
    s_waitcnt lgkmcnt(2)
    v_mfma_f32_16x16x32_bf16 v[32:35], v[40:43], v[40:43], v[32:35]
    v_mfma_f32_16x16x32_bf16 v[36:39], v[44:47], v[44:47], v[36:39]
    v_smfmac_f32_16x16x64_bf16 v[28:31], v[16:19], v[40:47], v13
    v_smfmac_f32_16x16x64_bf16 v[20:23], v[16:19], v[112:119], v13
    v_smfmac_f32_16x16x64_bf16 v[24:27], v[16:19], v[120:127], v13
    v_mfma_f32_16x16x32_bf16 v[128:131], v[40:43], v[112:115], v[128:131]
    v_mfma_f32_16x16x32_bf16 v[132:135], v[40:43], v[116:119], v[132:135]
    v_mfma_f32_16x16x32_bf16 v[136:139], v[40:43], v[120:123], v[136:139]
    v_mfma_f32_16x16x32_bf16 v[140:143], v[40:43], v[124:127], v[140:143]
    ds_read_b128 v[40:43], v6 offset:0
    v_cndmask_b32 v32, 0, v32, s[56:57]
    v_mfma_f32_16x16x32_bf16 v[144:147], v[44:47], v[112:115], v[144:147]
    v_cndmask_b32 v36, 0, v36, s[56:57]
    v_cndmask_b32 v32, v32, v33, s[58:59]
    v_mfma_f32_16x16x32_bf16 v[148:151], v[44:47], v[116:119], v[148:151]
    v_cndmask_b32 v36, v36, v37, s[58:59]
    v_cndmask_b32 v32, v32, v34, s[60:61]
    v_mfma_f32_16x16x32_bf16 v[152:155], v[44:47], v[120:123], v[152:155]
    v_cndmask_b32 v36, v36, v38, s[60:61]
    v_cndmask_b32 v32, v32, v35, s[62:63]
    v_mfma_f32_16x16x32_bf16 v[156:159], v[44:47], v[124:127], v[156:159]
    ds_read_b128 v[44:47], v6 offset:2048
    v_cndmask_b32 v36, v36, v39, s[62:63]
    v_add_f32 v28, v28, v29
    v_add_f32 v30, v30, v31
    v_permlane32_swap_b32 v32, v36
    v_cndmask_b32 v28, v30, v28, vcc
    v_add_f32 v32, v32, v36
    v_mul_f32 v28, 0xb9cccccd, v28
    v_mov_b32 v36, v32
    v_and_b32 v29, 0xffff0000, v28
    v_sub_f32 v30, v28, v29
    v_permlane16_swap_b32 v32, v36
    v_mul_f32 v28, v28, v28
    v_add_f32 v32, v32, v36
    v_cvt_pk_bf16_f32 v16, v29, v29
    v_mul_f32 v32, 0x3acccccd, v32
    v_fmac_f32 v32, 0xc1800000, v28
    v_max_f32 v32, 0, v32
    v_add_f32 v32, 0x3727c5ac, v32
    v_rsq_f32 v18, v32
    v_cvt_pk_bf16_f32 v17, v30, v30
    ds_write_b64 v15, v[16:17]
    ds_write_b32 v62, v18
    s_waitcnt lgkmcnt(0)
    s_barrier
    v_xor_b32 v0, 0, v14
    v_xor_b32 v1, 128, v14
    v_xor_b32 v2, 256, v14
    v_xor_b32 v3, 384, v14
    v_mfma_f32_16x16x32_bf16 v[160:163], v[48:51], v[112:115], v[160:163]
    ds_read_b64 v[28:29], v56 offset:0
    v_add_f32 v20, v20, v21
    v_mfma_f32_16x16x32_bf16 v[164:167], v[48:51], v[116:119], v[164:167]
    ds_read_b128 v[64:67], v0 offset:0
    v_add_f32 v22, v22, v23
    v_mfma_f32_16x16x32_bf16 v[168:171], v[48:51], v[120:123], v[168:171]
    ds_read_b64 v[30:31], v56 offset:256
    v_add_f32 v24, v24, v25
    v_mfma_f32_16x16x32_bf16 v[172:175], v[48:51], v[124:127], v[172:175]
    ds_read_b128 v[68:71], v0 offset:64
    v_add_f32 v26, v26, v27
    v_mfma_f32_16x16x32_bf16 v[176:179], v[76:79], v[96:99], v[176:179]
    ds_read_b128 v[48:51], v7 offset:0
    v_and_b32 v21, 0xffff0000, v20
    v_mfma_f32_16x16x32_bf16 v[180:183], v[76:79], v[100:103], v[180:183]
    ds_read_b64 v[32:33], v57 offset:0
    v_and_b32 v23, 0xffff0000, v22
    v_mfma_f32_16x16x32_bf16 v[184:187], v[76:79], v[104:107], v[184:187]
    ds_read_b128 v[72:75], v1 offset:0
    v_and_b32 v25, 0xffff0000, v24
    v_mfma_f32_16x16x32_bf16 v[188:191], v[76:79], v[108:111], v[188:191]
    ds_read_b64 v[34:35], v57 offset:256
    v_and_b32 v27, 0xffff0000, v26
    v_mfma_f32_16x16x32_bf16 v[176:179], v[52:55], v[112:115], v[176:179]
    ds_read_b128 v[76:79], v1 offset:64
    v_sub_f32 v20, v20, v21
    v_mfma_f32_16x16x32_bf16 v[180:183], v[52:55], v[116:119], v[180:183]
    ds_read_b64 v[36:37], v58 offset:0
    v_sub_f32 v22, v22, v23
    v_sub_f32 v24, v24, v25
    v_sub_f32 v26, v26, v27
    v_cvt_pk_bf16_f32 v20, v21, v20
    v_cvt_pk_bf16_f32 v22, v23, v22
    v_cvt_pk_bf16_f32 v24, v25, v24
    v_cvt_pk_bf16_f32 v26, v27, v26
    v_mov_b32 v21, v20
    v_mov_b32 v23, v22
    v_mov_b32 v25, v24
    v_mov_b32 v27, v26
    s_waitcnt lgkmcnt(8)
    v_mfma_f32_16x16x16_bf16 v[128:131], v[28:29], v[20:21], v[128:131]
    ds_read_b64 v[38:39], v58 offset:256
    v_mfma_f32_16x16x16_bf16 v[132:135], v[28:29], v[22:23], v[132:135]
    v_mfma_f32_16x16x16_bf16 v[136:139], v[28:29], v[24:25], v[136:139]
    v_mfma_f32_16x16x16_bf16 v[140:143], v[28:29], v[26:27], v[140:143]
    ds_read_b64 v[28:29], v59 offset:0
    s_waitcnt lgkmcnt(8)
    v_mfma_f32_16x16x16_bf16 v[144:147], v[30:31], v[20:21], v[144:147]
    v_mfma_f32_16x16x16_bf16 v[148:151], v[30:31], v[22:23], v[148:151]
    v_pk_mul_f32 v[128:129], v[128:129], v[64:65]
    v_mfma_f32_16x16x16_bf16 v[152:155], v[30:31], v[24:25], v[152:155]
    v_pk_mul_f32 v[130:131], v[130:131], v[66:67]
    v_mfma_f32_16x16x16_bf16 v[156:159], v[30:31], v[26:27], v[156:159]
    ds_read_b64 v[30:31], v59 offset:256
    v_pk_mul_f32 v[132:133], v[132:133], v[64:65]
    s_waitcnt lgkmcnt(6)
    v_mfma_f32_16x16x16_bf16 v[160:163], v[32:33], v[20:21], v[160:163]
    v_pk_mul_f32 v[134:135], v[134:135], v[66:67]
    v_mfma_f32_16x16x16_bf16 v[164:167], v[32:33], v[22:23], v[164:167]
    v_cvt_pk_bf16_f32 v128, v128, v129
    v_cvt_pk_bf16_f32 v129, v130, v131
    v_mfma_f32_16x16x16_bf16 v[168:171], v[32:33], v[24:25], v[168:171]
    v_cvt_pk_bf16_f32 v130, v132, v133
    v_cvt_pk_bf16_f32 v131, v134, v135
    v_mfma_f32_16x16x16_bf16 v[172:175], v[32:33], v[26:27], v[172:175]
    v_pk_mul_f32 v[136:137], v[136:137], v[64:65]
    v_pk_mul_f32 v[138:139], v[138:139], v[66:67]
    v_permlane16_swap_b32 v128, v130
    v_mfma_f32_16x16x32_bf16 v[184:187], v[52:55], v[120:123], v[184:187]
    v_permlane16_swap_b32 v129, v131
    buffer_store_dwordx4 v[128:131], v12, s[28:31], s48 offen offset:0 sc1
    v_mfma_f32_16x16x32_bf16 v[188:191], v[52:55], v[124:127], v[188:191]
    ds_read_b128 v[52:55], v7 offset:2048
    v_pk_mul_f32 v[140:141], v[140:141], v[64:65]
    v_pk_mul_f32 v[142:143], v[142:143], v[66:67]
    v_cvt_pk_bf16_f32 v136, v136, v137
    s_waitcnt lgkmcnt(5)
    v_mfma_f32_16x16x16_bf16 v[176:179], v[34:35], v[20:21], v[176:179]
    v_cvt_pk_bf16_f32 v137, v138, v139
    v_cvt_pk_bf16_f32 v138, v140, v141
    v_cvt_pk_bf16_f32 v139, v142, v143
    v_mfma_f32_16x16x16_bf16 v[180:183], v[34:35], v[22:23], v[180:183]
    v_permlane16_swap_b32 v136, v138
    v_mfma_f32_16x16x16_bf16 v[184:187], v[34:35], v[24:25], v[184:187]
    v_permlane16_swap_b32 v137, v139
    buffer_store_dwordx4 v[136:139], v12, s[28:31], s48 offen offset:512 sc1
    v_pk_mul_f32 v[144:145], v[144:145], v[68:69]
    v_mfma_f32_16x16x16_bf16 v[188:191], v[34:35], v[26:27], v[188:191]
    v_pk_mul_f32 v[146:147], v[146:147], v[70:71]
    v_pk_mul_f32 v[148:149], v[148:149], v[68:69]
    v_mfma_f32_16x16x32_bf16 v[192:195], v[80:83], v[96:99], v[192:195]
    v_pk_mul_f32 v[150:151], v[150:151], v[70:71]
    v_cvt_pk_bf16_f32 v144, v144, v145
    v_cvt_pk_bf16_f32 v145, v146, v147
    v_mfma_f32_16x16x32_bf16 v[196:199], v[80:83], v[100:103], v[196:199]
    v_cvt_pk_bf16_f32 v146, v148, v149
    v_cvt_pk_bf16_f32 v147, v150, v151
    v_pk_mul_f32 v[152:153], v[152:153], v[68:69]
    v_mfma_f32_16x16x32_bf16 v[200:203], v[80:83], v[104:107], v[200:203]
    v_pk_mul_f32 v[154:155], v[154:155], v[70:71]
    v_permlane16_swap_b32 v144, v146
    v_mfma_f32_16x16x32_bf16 v[204:207], v[80:83], v[108:111], v[204:207]
    ds_read_b128 v[80:83], v2 offset:0
    v_permlane16_swap_b32 v145, v147
    buffer_store_dwordx4 v[144:147], v12, s[28:31], s49 offen offset:0 sc1
    v_pk_mul_f32 v[156:157], v[156:157], v[68:69]
    v_mfma_f32_16x16x32_bf16 v[192:195], v[40:43], v[112:115], v[192:195]
    v_pk_mul_f32 v[158:159], v[158:159], v[70:71]
    v_cvt_pk_bf16_f32 v152, v152, v153
    v_mfma_f32_16x16x32_bf16 v[196:199], v[40:43], v[116:119], v[196:199]
    v_cvt_pk_bf16_f32 v153, v154, v155
    v_cvt_pk_bf16_f32 v154, v156, v157
    v_cvt_pk_bf16_f32 v155, v158, v159
    v_mfma_f32_16x16x32_bf16 v[200:203], v[40:43], v[120:123], v[200:203]
    v_permlane16_swap_b32 v152, v154
    v_permlane16_swap_b32 v153, v155
    v_mfma_f32_16x16x32_bf16 v[204:207], v[40:43], v[124:127], v[204:207]
    buffer_store_dwordx4 v[152:155], v12, s[28:31], s49 offen offset:512 sc1
    v_pk_mul_f32 v[160:161], v[160:161], v[72:73]
    s_waitcnt lgkmcnt(0)
    v_mfma_f32_16x16x16_bf16 v[192:195], v[36:37], v[20:21], v[192:195]
    v_pk_mul_f32 v[162:163], v[162:163], v[74:75]
    v_pk_mul_f32 v[164:165], v[164:165], v[72:73]
    v_pk_mul_f32 v[166:167], v[166:167], v[74:75]
    v_mfma_f32_16x16x16_bf16 v[196:199], v[36:37], v[22:23], v[196:199]
    v_cvt_pk_bf16_f32 v160, v160, v161
    v_cvt_pk_bf16_f32 v161, v162, v163
    v_mfma_f32_16x16x16_bf16 v[200:203], v[36:37], v[24:25], v[200:203]
    v_cvt_pk_bf16_f32 v162, v164, v165
    v_cvt_pk_bf16_f32 v163, v166, v167
    v_pk_mul_f32 v[168:169], v[168:169], v[72:73]
    v_mfma_f32_16x16x16_bf16 v[204:207], v[36:37], v[26:27], v[204:207]
    v_pk_mul_f32 v[170:171], v[170:171], v[74:75]
    v_permlane16_swap_b32 v160, v162
    v_permlane16_swap_b32 v161, v163
    v_mfma_f32_16x16x32_bf16 v[208:211], v[84:87], v[96:99], v[208:211]
    buffer_store_dwordx4 v[160:163], v12, s[28:31], s50 offen offset:0 sc1
    v_pk_mul_f32 v[172:173], v[172:173], v[72:73]
    v_mfma_f32_16x16x32_bf16 v[212:215], v[84:87], v[100:103], v[212:215]
    v_pk_mul_f32 v[174:175], v[174:175], v[74:75]
    v_cvt_pk_bf16_f32 v168, v168, v169
    v_cvt_pk_bf16_f32 v169, v170, v171
    v_mfma_f32_16x16x32_bf16 v[216:219], v[84:87], v[104:107], v[216:219]
    v_cvt_pk_bf16_f32 v170, v172, v173
    v_cvt_pk_bf16_f32 v171, v174, v175
    v_mfma_f32_16x16x32_bf16 v[220:223], v[84:87], v[108:111], v[220:223]
    ds_read_b128 v[84:87], v2 offset:64
    v_permlane16_swap_b32 v168, v170
    v_permlane16_swap_b32 v169, v171
    v_mfma_f32_16x16x32_bf16 v[208:211], v[44:47], v[112:115], v[208:211]
    buffer_store_dwordx4 v[168:171], v12, s[28:31], s50 offen offset:512 sc1
    v_pk_mul_f32 v[176:177], v[176:177], v[76:77]
    v_pk_mul_f32 v[178:179], v[178:179], v[78:79]
    v_mfma_f32_16x16x32_bf16 v[212:215], v[44:47], v[116:119], v[212:215]
    v_pk_mul_f32 v[180:181], v[180:181], v[76:77]
    v_pk_mul_f32 v[182:183], v[182:183], v[78:79]
    v_mfma_f32_16x16x32_bf16 v[216:219], v[44:47], v[120:123], v[216:219]
    v_cvt_pk_bf16_f32 v176, v176, v177
    v_cvt_pk_bf16_f32 v177, v178, v179
    v_cvt_pk_bf16_f32 v178, v180, v181
    v_mfma_f32_16x16x32_bf16 v[220:223], v[44:47], v[124:127], v[220:223]
    v_cvt_pk_bf16_f32 v179, v182, v183
    v_pk_mul_f32 v[184:185], v[184:185], v[76:77]
    s_waitcnt lgkmcnt(0)
    v_mfma_f32_16x16x16_bf16 v[208:211], v[38:39], v[20:21], v[208:211]
    v_pk_mul_f32 v[186:187], v[186:187], v[78:79]
    v_permlane16_swap_b32 v176, v178
    v_permlane16_swap_b32 v177, v179
    v_mfma_f32_16x16x16_bf16 v[212:215], v[38:39], v[22:23], v[212:215]
    buffer_store_dwordx4 v[176:179], v12, s[28:31], s51 offen offset:0 sc1
    v_pk_mul_f32 v[188:189], v[188:189], v[76:77]
    v_pk_mul_f32 v[190:191], v[190:191], v[78:79]
    v_mfma_f32_16x16x16_bf16 v[216:219], v[38:39], v[24:25], v[216:219]
    v_cvt_pk_bf16_f32 v184, v184, v185
    v_cvt_pk_bf16_f32 v185, v186, v187
    v_mfma_f32_16x16x16_bf16 v[220:223], v[38:39], v[26:27], v[220:223]
    v_cvt_pk_bf16_f32 v186, v188, v189
    v_cvt_pk_bf16_f32 v187, v190, v191
    v_mfma_f32_16x16x32_bf16 v[224:227], v[88:91], v[96:99], v[224:227]
    v_permlane16_swap_b32 v184, v186
    v_permlane16_swap_b32 v185, v187
    v_mfma_f32_16x16x32_bf16 v[228:231], v[88:91], v[100:103], v[228:231]
    buffer_store_dwordx4 v[184:187], v12, s[28:31], s51 offen offset:512 sc1
    v_pk_mul_f32 v[192:193], v[192:193], v[80:81]
    v_pk_mul_f32 v[194:195], v[194:195], v[82:83]
    v_mfma_f32_16x16x32_bf16 v[232:235], v[88:91], v[104:107], v[232:235]
    v_pk_mul_f32 v[196:197], v[196:197], v[80:81]
    v_pk_mul_f32 v[198:199], v[198:199], v[82:83]
    v_cvt_pk_bf16_f32 v192, v192, v193
    v_mfma_f32_16x16x32_bf16 v[236:239], v[88:91], v[108:111], v[236:239]
    ds_read_b128 v[88:91], v3 offset:0
    v_cvt_pk_bf16_f32 v193, v194, v195
    v_cvt_pk_bf16_f32 v194, v196, v197
    v_mfma_f32_16x16x32_bf16 v[224:227], v[48:51], v[112:115], v[224:227]
    v_cvt_pk_bf16_f32 v195, v198, v199
    v_pk_mul_f32 v[200:201], v[200:201], v[80:81]
    v_pk_mul_f32 v[202:203], v[202:203], v[82:83]
    v_mfma_f32_16x16x32_bf16 v[228:231], v[48:51], v[116:119], v[228:231]
    v_permlane16_swap_b32 v192, v194
    v_permlane16_swap_b32 v193, v195
    v_mfma_f32_16x16x32_bf16 v[232:235], v[48:51], v[120:123], v[232:235]
    buffer_store_dwordx4 v[192:195], v12, s[28:31], s52 offen offset:0 sc1
    v_pk_mul_f32 v[204:205], v[204:205], v[80:81]
    v_pk_mul_f32 v[206:207], v[206:207], v[82:83]
    v_mfma_f32_16x16x32_bf16 v[236:239], v[48:51], v[124:127], v[236:239]
    v_cvt_pk_bf16_f32 v200, v200, v201
    v_cvt_pk_bf16_f32 v201, v202, v203
    v_cvt_pk_bf16_f32 v202, v204, v205
    s_waitcnt lgkmcnt(0)
    v_mfma_f32_16x16x16_bf16 v[224:227], v[28:29], v[20:21], v[224:227]
    v_cvt_pk_bf16_f32 v203, v206, v207
    v_mfma_f32_16x16x16_bf16 v[228:231], v[28:29], v[22:23], v[228:231]
    v_permlane16_swap_b32 v200, v202
    v_permlane16_swap_b32 v201, v203
    buffer_store_dwordx4 v[200:203], v12, s[28:31], s52 offen offset:512 sc1
    v_mfma_f32_16x16x16_bf16 v[232:235], v[28:29], v[24:25], v[232:235]
    v_pk_mul_f32 v[208:209], v[208:209], v[84:85]
    v_pk_mul_f32 v[210:211], v[210:211], v[86:87]
    v_mfma_f32_16x16x16_bf16 v[236:239], v[28:29], v[26:27], v[236:239]
    v_pk_mul_f32 v[212:213], v[212:213], v[84:85]
    v_pk_mul_f32 v[214:215], v[214:215], v[86:87]
    v_cvt_pk_bf16_f32 v208, v208, v209
    v_mfma_f32_16x16x32_bf16 v[240:243], v[92:95], v[96:99], v[240:243]
    v_cvt_pk_bf16_f32 v209, v210, v211
    v_cvt_pk_bf16_f32 v210, v212, v213
    v_cvt_pk_bf16_f32 v211, v214, v215
    v_mfma_f32_16x16x32_bf16 v[244:247], v[92:95], v[100:103], v[244:247]
    v_pk_mul_f32 v[216:217], v[216:217], v[84:85]
    v_pk_mul_f32 v[218:219], v[218:219], v[86:87]
    v_mfma_f32_16x16x32_bf16 v[248:251], v[92:95], v[104:107], v[248:251]
    v_permlane16_swap_b32 v208, v210
    v_permlane16_swap_b32 v209, v211
    buffer_store_dwordx4 v[208:211], v12, s[28:31], s53 offen offset:0 sc1
    v_mfma_f32_16x16x32_bf16 v[252:255], v[92:95], v[108:111], v[252:255]
    ds_read_b128 v[92:95], v3 offset:64
    v_pk_mul_f32 v[220:221], v[220:221], v[84:85]
    v_pk_mul_f32 v[222:223], v[222:223], v[86:87]
    v_mfma_f32_16x16x32_bf16 v[240:243], v[52:55], v[112:115], v[240:243]
    v_cvt_pk_bf16_f32 v216, v216, v217
    v_cvt_pk_bf16_f32 v217, v218, v219
    v_cvt_pk_bf16_f32 v218, v220, v221
    v_mfma_f32_16x16x32_bf16 v[244:247], v[52:55], v[116:119], v[244:247]
    v_cvt_pk_bf16_f32 v219, v222, v223
    v_permlane16_swap_b32 v216, v218
    v_mfma_f32_16x16x32_bf16 v[248:251], v[52:55], v[120:123], v[248:251]
    v_permlane16_swap_b32 v217, v219
    buffer_store_dwordx4 v[216:219], v12, s[28:31], s53 offen offset:512 sc1
    v_mfma_f32_16x16x32_bf16 v[252:255], v[52:55], v[124:127], v[252:255]
    v_pk_mul_f32 v[224:225], v[224:225], v[88:89]
    v_pk_mul_f32 v[226:227], v[226:227], v[90:91]
    v_pk_mul_f32 v[228:229], v[228:229], v[88:89]
    s_waitcnt lgkmcnt(0)
    v_mfma_f32_16x16x16_bf16 v[240:243], v[30:31], v[20:21], v[240:243]
    v_pk_mul_f32 v[230:231], v[230:231], v[90:91]
    v_cvt_pk_bf16_f32 v224, v224, v225
    v_mfma_f32_16x16x16_bf16 v[244:247], v[30:31], v[22:23], v[244:247]
    v_cvt_pk_bf16_f32 v225, v226, v227
    v_cvt_pk_bf16_f32 v226, v228, v229
    v_cvt_pk_bf16_f32 v227, v230, v231
    v_mfma_f32_16x16x16_bf16 v[248:251], v[30:31], v[24:25], v[248:251]
    v_pk_mul_f32 v[232:233], v[232:233], v[88:89]
    v_pk_mul_f32 v[234:235], v[234:235], v[90:91]
    v_permlane16_swap_b32 v224, v226
    v_mfma_f32_16x16x16_bf16 v[252:255], v[30:31], v[26:27], v[252:255]
    v_permlane16_swap_b32 v225, v227
    buffer_store_dwordx4 v[224:227], v12, s[28:31], s54 offen offset:0 sc1
    v_pk_mul_f32 v[236:237], v[236:237], v[88:89]
    v_pk_mul_f32 v[238:239], v[238:239], v[90:91]
    v_cvt_pk_bf16_f32 v232, v232, v233
    v_cvt_pk_bf16_f32 v233, v234, v235
    v_cvt_pk_bf16_f32 v234, v236, v237
    v_cvt_pk_bf16_f32 v235, v238, v239
    s_nop 0
    v_permlane16_swap_b32 v232, v234
    v_permlane16_swap_b32 v233, v235
    buffer_store_dwordx4 v[232:235], v12, s[28:31], s54 offen offset:512 sc1
    v_pk_mul_f32 v[240:241], v[240:241], v[92:93]
    v_pk_mul_f32 v[242:243], v[242:243], v[94:95]
    v_pk_mul_f32 v[244:245], v[244:245], v[92:93]
    v_pk_mul_f32 v[246:247], v[246:247], v[94:95]
    v_cvt_pk_bf16_f32 v240, v240, v241
    v_cvt_pk_bf16_f32 v241, v242, v243
    v_cvt_pk_bf16_f32 v242, v244, v245
    v_cvt_pk_bf16_f32 v243, v246, v247
    v_pk_mul_f32 v[248:249], v[248:249], v[92:93]
    v_pk_mul_f32 v[250:251], v[250:251], v[94:95]
    v_permlane16_swap_b32 v240, v242
    v_permlane16_swap_b32 v241, v243
    buffer_store_dwordx4 v[240:243], v12, s[28:31], s55 offen offset:0 sc1
    v_pk_mul_f32 v[252:253], v[252:253], v[92:93]
    v_pk_mul_f32 v[254:255], v[254:255], v[94:95]
    v_cvt_pk_bf16_f32 v248, v248, v249
    v_cvt_pk_bf16_f32 v249, v250, v251
    v_cvt_pk_bf16_f32 v250, v252, v253
    v_cvt_pk_bf16_f32 v251, v254, v255
    s_nop 0
    v_permlane16_swap_b32 v248, v250
    v_permlane16_swap_b32 v249, v251
    buffer_store_dwordx4 v[248:251], v12, s[28:31], s55 offen offset:512 sc1
    s_endpgm
k1_relay:
    v_lshrrev_b32 v40, 4, v46
    v_and_b32 v42, 15, v46
    v_lshlrev_b32 v43, 1, v40
    v_xor_b32 v42, v42, v43
    v_lshlrev_b32 v42, 4, v42
    v_xor_b32 v43, 128, v42
    v_mul_u32_u24 v41, 1280, v40
    v_add_u32 v4, v41, v42
    v_add_u32 v5, v41, v43
    v_bfe_u32 v41, v46, 2, 2
    v_lshl_add_u32 v41, v40, 2, v41
    v_and_b32 v42, 7, v41
    v_lshlrev_b32 v41, 8, v41
    v_lshl_add_u32 v41, v42, 5, v41
    v_and_b32 v42, 3, v46
    v_lshl_add_u32 v41, v42, 3, v41
    s_lshl_b32 s41, s32, 14
    v_add_u32 v6, s41, v41
    v_xor_b32 v8, 0, v6
    v_xor_b32 v9, 32, v6
    v_xor_b32 v10, 64, v6
    v_xor_b32 v11, 96, v6
    v_xor_b32 v12, 128, v6
    v_xor_b32 v13, 160, v6
    v_xor_b32 v14, 192, v6
    v_xor_b32 v15, 224, v6
    v_lshlrev_b32 v7, 4, v46
    s_lshl_b32 s42, s33, 3
    s_add_u32 s42, s42, s32
    s_waitcnt lgkmcnt(0)
    s_add_u32 s28, s16, 17563648
    s_addc_u32 s29, s17, 0
    s_mov_b32 s30, 3031040
    s_mov_b32 s31, 0x00020000
    s_add_u32 s35, s42, 0
    s_mul_i32 s36, s35, 205
    s_lshr_b32 s36, s36, 10
    s_mul_i32 s37, s36, 5
    s_sub_u32 s37, s35, s37
    s_lshl_b32 s55, s35, 13
    s_lshl_b32 s43, s37, 8
    s_lshl_b32 s38, s36, 5
    s_mov_b32 s44, 20480
    s_mov_b32 s45, 10240
    s_mov_b32 s46, 5120
    s_sub_u32 s37, s36, 54
    s_mul_i32 s37, s37, 40
    s_cmp_ge_u32 s36, 54
    s_cselect_b32 s24, s8, s14
    s_cselect_b32 s25, s9, s15
    s_mov_b32 s26, 2211840
    s_cselect_b32 s26, 819200, s26
    s_mov_b32 s27, 0x00020000
    s_cselect_b32 s38, s37, s38
    s_cselect_b32 s44, 5120, s44
    s_cselect_b32 s45, 25600, s45
    s_cselect_b32 s46, 10240, s46
    s_sub_u32 s37, s36, 70
    s_mul_i32 s37, s37, 160
    s_add_u32 s37, s37, 16
    s_cmp_ge_u32 s36, 70
    s_cselect_b32 s38, s37, s38
    s_cselect_b32 s44, 25600, s44
    s_cselect_b32 s45, 51200, s45
    s_cselect_b32 s46, 102400, s46
    s_mul_i32 s38, s38, 1280
    s_add_u32 s43, s43, s38
    s_mov_b32 s35, s43
    s_add_u32 m0, s41, 0
    s_nop 0
    buffer_load_dwordx4 v4, s[24:27], s35 offen lds
    s_mov_b32 s35, s43
    s_add_u32 s35, s35, s44
    s_add_u32 m0, s41, 1024
    s_nop 0
    buffer_load_dwordx4 v5, s[24:27], s35 offen lds
    s_mov_b32 s35, s43
    s_add_u32 s35, s35, s45
    s_add_u32 m0, s41, 2048
    s_nop 0
    buffer_load_dwordx4 v4, s[24:27], s35 offen lds
    s_mov_b32 s35, s43
    s_add_u32 s35, s35, s44
    s_add_u32 s35, s35, s45
    s_add_u32 m0, s41, 3072
    s_nop 0
    buffer_load_dwordx4 v5, s[24:27], s35 offen lds
    s_mov_b32 s35, s43
    s_add_u32 s35, s35, s46
    s_add_u32 m0, s41, 4096
    s_nop 0
    buffer_load_dwordx4 v4, s[24:27], s35 offen lds
    s_mov_b32 s35, s43
    s_add_u32 s35, s35, s44
    s_add_u32 s35, s35, s46
    s_add_u32 m0, s41, 5120
    s_nop 0
    buffer_load_dwordx4 v5, s[24:27], s35 offen lds
    s_mov_b32 s35, s43
    s_add_u32 s35, s35, s45
    s_add_u32 s35, s35, s46
    s_add_u32 m0, s41, 6144
    s_nop 0
    buffer_load_dwordx4 v4, s[24:27], s35 offen lds
    s_mov_b32 s35, s43
    s_add_u32 s35, s35, s44
    s_add_u32 s35, s35, s45
    s_add_u32 s35, s35, s46
    s_add_u32 m0, s41, 7168
    s_nop 0
    buffer_load_dwordx4 v5, s[24:27], s35 offen lds
    s_add_u32 s35, s42, 128
    s_mul_i32 s36, s35, 205
    s_lshr_b32 s36, s36, 10
    s_mul_i32 s37, s36, 5
    s_sub_u32 s37, s35, s37
    s_lshl_b32 s56, s35, 13
    s_lshl_b32 s43, s37, 8
    s_lshl_b32 s38, s36, 5
    s_mov_b32 s44, 20480
    s_mov_b32 s45, 10240
    s_mov_b32 s46, 5120
    s_sub_u32 s37, s36, 54
    s_mul_i32 s37, s37, 40
    s_cmp_ge_u32 s36, 54
    s_cselect_b32 s24, s8, s14
    s_cselect_b32 s25, s9, s15
    s_mov_b32 s26, 2211840
    s_cselect_b32 s26, 819200, s26
    s_mov_b32 s27, 0x00020000
    s_cselect_b32 s38, s37, s38
    s_cselect_b32 s44, 5120, s44
    s_cselect_b32 s45, 25600, s45
    s_cselect_b32 s46, 10240, s46
    s_sub_u32 s37, s36, 70
    s_mul_i32 s37, s37, 160
    s_add_u32 s37, s37, 16
    s_cmp_ge_u32 s36, 70
    s_cselect_b32 s38, s37, s38
    s_cselect_b32 s44, 25600, s44
    s_cselect_b32 s45, 51200, s45
    s_cselect_b32 s46, 102400, s46
    s_mul_i32 s38, s38, 1280
    s_add_u32 s43, s43, s38
    s_mov_b32 s35, s43
    s_add_u32 m0, s41, 8192
    s_nop 0
    buffer_load_dwordx4 v4, s[24:27], s35 offen lds
    s_mov_b32 s35, s43
    s_add_u32 s35, s35, s44
    s_add_u32 m0, s41, 9216
    s_nop 0
    buffer_load_dwordx4 v5, s[24:27], s35 offen lds
    s_mov_b32 s35, s43
    s_add_u32 s35, s35, s45
    s_add_u32 m0, s41, 10240
    s_nop 0
    buffer_load_dwordx4 v4, s[24:27], s35 offen lds
    s_mov_b32 s35, s43
    s_add_u32 s35, s35, s44
    s_add_u32 s35, s35, s45
    s_add_u32 m0, s41, 11264
    s_nop 0
    buffer_load_dwordx4 v5, s[24:27], s35 offen lds
    s_mov_b32 s35, s43
    s_add_u32 s35, s35, s46
    s_add_u32 m0, s41, 12288
    s_nop 0
    buffer_load_dwordx4 v4, s[24:27], s35 offen lds
    s_mov_b32 s35, s43
    s_add_u32 s35, s35, s44
    s_add_u32 s35, s35, s46
    s_add_u32 m0, s41, 13312
    s_nop 0
    buffer_load_dwordx4 v5, s[24:27], s35 offen lds
    s_mov_b32 s35, s43
    s_add_u32 s35, s35, s45
    s_add_u32 s35, s35, s46
    s_add_u32 m0, s41, 14336
    s_nop 0
    buffer_load_dwordx4 v4, s[24:27], s35 offen lds
    s_mov_b32 s35, s43
    s_add_u32 s35, s35, s44
    s_add_u32 s35, s35, s45
    s_add_u32 s35, s35, s46
    s_add_u32 m0, s41, 15360
    s_nop 0
    buffer_load_dwordx4 v5, s[24:27], s35 offen lds
    s_waitcnt vmcnt(8)
    ds_read_b64_tr_b16 v[32:33], v8 offset:0
    ds_read_b64_tr_b16 v[34:35], v8 offset:4096
    ds_read_b64_tr_b16 v[36:37], v9 offset:0
    ds_read_b64_tr_b16 v[38:39], v9 offset:4096
    ds_read_b64_tr_b16 v[40:41], v10 offset:0
    ds_read_b64_tr_b16 v[42:43], v10 offset:4096
    ds_read_b64_tr_b16 v[44:45], v11 offset:0
    ds_read_b64_tr_b16 v[46:47], v11 offset:4096
    ds_read_b64_tr_b16 v[48:49], v12 offset:0
    ds_read_b64_tr_b16 v[50:51], v12 offset:4096
    ds_read_b64_tr_b16 v[52:53], v13 offset:0
    ds_read_b64_tr_b16 v[54:55], v13 offset:4096
    ds_read_b64_tr_b16 v[56:57], v14 offset:0
    ds_read_b64_tr_b16 v[58:59], v14 offset:4096
    ds_read_b64_tr_b16 v[60:61], v15 offset:0
    ds_read_b64_tr_b16 v[62:63], v15 offset:4096
    s_waitcnt lgkmcnt(14)
    buffer_store_dwordx4 v[32:35], v7, s[28:31], s55 offen offset:0 sc1
    s_waitcnt lgkmcnt(12)
    buffer_store_dwordx4 v[36:39], v7, s[28:31], s55 offen offset:1024 sc1
    s_waitcnt lgkmcnt(10)
    buffer_store_dwordx4 v[40:43], v7, s[28:31], s55 offen offset:2048 sc1
    s_waitcnt lgkmcnt(8)
    buffer_store_dwordx4 v[44:47], v7, s[28:31], s55 offen offset:3072 sc1
    s_add_u32 s55, s55, 4096
    s_waitcnt lgkmcnt(6)
    buffer_store_dwordx4 v[48:51], v7, s[28:31], s55 offen offset:0 sc1
    s_waitcnt lgkmcnt(4)
    buffer_store_dwordx4 v[52:55], v7, s[28:31], s55 offen offset:1024 sc1
    s_waitcnt lgkmcnt(2)
    buffer_store_dwordx4 v[56:59], v7, s[28:31], s55 offen offset:2048 sc1
    s_waitcnt lgkmcnt(0)
    buffer_store_dwordx4 v[60:63], v7, s[28:31], s55 offen offset:3072 sc1
    s_add_u32 s35, s42, 256
    s_mul_i32 s36, s35, 205
    s_lshr_b32 s36, s36, 10
    s_mul_i32 s37, s36, 5
    s_sub_u32 s37, s35, s37
    s_lshl_b32 s57, s35, 13
    s_lshl_b32 s43, s37, 8
    s_lshl_b32 s38, s36, 5
    s_mov_b32 s44, 20480
    s_mov_b32 s45, 10240
    s_mov_b32 s46, 5120
    s_sub_u32 s37, s36, 54
    s_mul_i32 s37, s37, 40
    s_cmp_ge_u32 s36, 54
    s_cselect_b32 s24, s8, s14
    s_cselect_b32 s25, s9, s15
    s_mov_b32 s26, 2211840
    s_cselect_b32 s26, 819200, s26
    s_mov_b32 s27, 0x00020000
    s_cselect_b32 s38, s37, s38
    s_cselect_b32 s44, 5120, s44
    s_cselect_b32 s45, 25600, s45
    s_cselect_b32 s46, 10240, s46
    s_sub_u32 s37, s36, 70
    s_mul_i32 s37, s37, 160
    s_add_u32 s37, s37, 16
    s_cmp_ge_u32 s36, 70
    s_cselect_b32 s38, s37, s38
    s_cselect_b32 s44, 25600, s44
    s_cselect_b32 s45, 51200, s45
    s_cselect_b32 s46, 102400, s46
    s_mul_i32 s38, s38, 1280
    s_add_u32 s43, s43, s38
    s_mov_b32 s35, s43
    s_add_u32 m0, s41, 0
    s_nop 0
    buffer_load_dwordx4 v4, s[24:27], s35 offen lds
    s_mov_b32 s35, s43
    s_add_u32 s35, s35, s44
    s_add_u32 m0, s41, 1024
    s_nop 0
    buffer_load_dwordx4 v5, s[24:27], s35 offen lds
    s_mov_b32 s35, s43
    s_add_u32 s35, s35, s45
    s_add_u32 m0, s41, 2048
    s_nop 0
    buffer_load_dwordx4 v4, s[24:27], s35 offen lds
    s_mov_b32 s35, s43
    s_add_u32 s35, s35, s44
    s_add_u32 s35, s35, s45
    s_add_u32 m0, s41, 3072
    s_nop 0
    buffer_load_dwordx4 v5, s[24:27], s35 offen lds
    s_mov_b32 s35, s43
    s_add_u32 s35, s35, s46
    s_add_u32 m0, s41, 4096
    s_nop 0
    buffer_load_dwordx4 v4, s[24:27], s35 offen lds
    s_mov_b32 s35, s43
    s_add_u32 s35, s35, s44
    s_add_u32 s35, s35, s46
    s_add_u32 m0, s41, 5120
    s_nop 0
    buffer_load_dwordx4 v5, s[24:27], s35 offen lds
    s_mov_b32 s35, s43
    s_add_u32 s35, s35, s45
    s_add_u32 s35, s35, s46
    s_add_u32 m0, s41, 6144
    s_nop 0
    buffer_load_dwordx4 v4, s[24:27], s35 offen lds
    s_mov_b32 s35, s43
    s_add_u32 s35, s35, s44
    s_add_u32 s35, s35, s45
    s_add_u32 s35, s35, s46
    s_add_u32 m0, s41, 7168
    s_nop 0
    buffer_load_dwordx4 v5, s[24:27], s35 offen lds
    s_waitcnt vmcnt(16)
    ds_read_b64_tr_b16 v[64:65], v8 offset:8192
    ds_read_b64_tr_b16 v[66:67], v8 offset:12288
    ds_read_b64_tr_b16 v[68:69], v9 offset:8192
    ds_read_b64_tr_b16 v[70:71], v9 offset:12288
    ds_read_b64_tr_b16 v[72:73], v10 offset:8192
    ds_read_b64_tr_b16 v[74:75], v10 offset:12288
    ds_read_b64_tr_b16 v[76:77], v11 offset:8192
    ds_read_b64_tr_b16 v[78:79], v11 offset:12288
    ds_read_b64_tr_b16 v[80:81], v12 offset:8192
    ds_read_b64_tr_b16 v[82:83], v12 offset:12288
    ds_read_b64_tr_b16 v[84:85], v13 offset:8192
    ds_read_b64_tr_b16 v[86:87], v13 offset:12288
    ds_read_b64_tr_b16 v[88:89], v14 offset:8192
    ds_read_b64_tr_b16 v[90:91], v14 offset:12288
    ds_read_b64_tr_b16 v[92:93], v15 offset:8192
    ds_read_b64_tr_b16 v[94:95], v15 offset:12288
    s_waitcnt lgkmcnt(14)
    buffer_store_dwordx4 v[64:67], v7, s[28:31], s56 offen offset:0 sc1
    s_waitcnt lgkmcnt(12)
    buffer_store_dwordx4 v[68:71], v7, s[28:31], s56 offen offset:1024 sc1
    s_waitcnt lgkmcnt(10)
    buffer_store_dwordx4 v[72:75], v7, s[28:31], s56 offen offset:2048 sc1
    s_waitcnt lgkmcnt(8)
    buffer_store_dwordx4 v[76:79], v7, s[28:31], s56 offen offset:3072 sc1
    s_add_u32 s56, s56, 4096
    s_waitcnt lgkmcnt(6)
    buffer_store_dwordx4 v[80:83], v7, s[28:31], s56 offen offset:0 sc1
    s_waitcnt lgkmcnt(4)
    buffer_store_dwordx4 v[84:87], v7, s[28:31], s56 offen offset:1024 sc1
    s_waitcnt lgkmcnt(2)
    buffer_store_dwordx4 v[88:91], v7, s[28:31], s56 offen offset:2048 sc1
    s_waitcnt lgkmcnt(0)
    buffer_store_dwordx4 v[92:95], v7, s[28:31], s56 offen offset:3072 sc1
    s_waitcnt vmcnt(8)
    ds_read_b64_tr_b16 v[32:33], v8 offset:0
    ds_read_b64_tr_b16 v[34:35], v8 offset:4096
    ds_read_b64_tr_b16 v[36:37], v9 offset:0
    ds_read_b64_tr_b16 v[38:39], v9 offset:4096
    ds_read_b64_tr_b16 v[40:41], v10 offset:0
    ds_read_b64_tr_b16 v[42:43], v10 offset:4096
    ds_read_b64_tr_b16 v[44:45], v11 offset:0
    ds_read_b64_tr_b16 v[46:47], v11 offset:4096
    ds_read_b64_tr_b16 v[48:49], v12 offset:0
    ds_read_b64_tr_b16 v[50:51], v12 offset:4096
    ds_read_b64_tr_b16 v[52:53], v13 offset:0
    ds_read_b64_tr_b16 v[54:55], v13 offset:4096
    ds_read_b64_tr_b16 v[56:57], v14 offset:0
    ds_read_b64_tr_b16 v[58:59], v14 offset:4096
    ds_read_b64_tr_b16 v[60:61], v15 offset:0
    ds_read_b64_tr_b16 v[62:63], v15 offset:4096
    s_waitcnt lgkmcnt(14)
    buffer_store_dwordx4 v[32:35], v7, s[28:31], s57 offen offset:0 sc1
    s_waitcnt lgkmcnt(12)
    buffer_store_dwordx4 v[36:39], v7, s[28:31], s57 offen offset:1024 sc1
    s_waitcnt lgkmcnt(10)
    buffer_store_dwordx4 v[40:43], v7, s[28:31], s57 offen offset:2048 sc1
    s_waitcnt lgkmcnt(8)
    buffer_store_dwordx4 v[44:47], v7, s[28:31], s57 offen offset:3072 sc1
    s_add_u32 s57, s57, 4096
    s_waitcnt lgkmcnt(6)
    buffer_store_dwordx4 v[48:51], v7, s[28:31], s57 offen offset:0 sc1
    s_waitcnt lgkmcnt(4)
    buffer_store_dwordx4 v[52:55], v7, s[28:31], s57 offen offset:1024 sc1
    s_waitcnt lgkmcnt(2)
    buffer_store_dwordx4 v[56:59], v7, s[28:31], s57 offen offset:2048 sc1
    s_waitcnt lgkmcnt(0)
    buffer_store_dwordx4 v[60:63], v7, s[28:31], s57 offen offset:3072 sc1
k1_exit:
    s_endpgm
.section .rodata,"a"
.p2align 6
.amdhsa_kernel proj_kernel
  .amdhsa_next_free_vgpr 256
  .amdhsa_next_free_sgpr 102
  .amdhsa_accum_offset 256
  .amdhsa_group_segment_fixed_size 0
  .amdhsa_kernarg_size 72
  .amdhsa_user_sgpr_count 2
  .amdhsa_user_sgpr_kernarg_segment_ptr 1
  .amdhsa_system_sgpr_workgroup_id_x 1
.end_amdhsa_kernel
.text
.globl attn_kernel
.p2align 8
.type attn_kernel,@function
attn_kernel:
    s_cmp_ge_u32 s2, 256
    s_cbranch_scc1 k2_exit
    s_load_dwordx2 s[4:5], s[0:1], 64
    s_load_dwordx2 s[6:7], s[0:1], 0
    s_load_dwordx2 s[64:65], s[0:1], 48
    v_lshrrev_b32 v2, 6, v0
    v_and_b32 v5, 63, v0
    s_and_b32 s38, s2, 7
    v_readfirstlane_b32 s20, v2
    s_lshl_b32 s21, s38, 2
    s_bfe_u32 s38, s2, 0x20003
    s_add_u32 s21, s21, s38
    s_lshr_b32 s22, s2, 5
    v_lshlrev_b32 v0, 4, v5
    s_mul_i32 s38, s21, 5
    s_cmp_ge_u32 s20, 8
    s_cbranch_scc1 k2_gemm
    s_and_b32 s23, s20, 1
    s_lshr_b32 s24, s20, 1
    s_setprio 2
    s_add_u32 s39, s38, 1
    s_lshr_b32 s39, s39, 1
    s_lshl_b32 s41, s39, 9
    s_lshr_b32 s39, s38, 1
    s_lshl_b32 s39, s39, 9
    s_bitcmp0_b32 s21, 0
    s_cselect_b32 s40, 1024, 8
    s_add_u32 s42, s39, s40
    s_mul_i32 s38, s24, 1310720
    s_add_u32 s38, s38, 40960
    s_add_u32 s25, s41, s38
    s_add_u32 s26, s42, s38
    s_lshl1_add_u32 s38, s22, s23
    s_lshl2_add_u32 s38, s38, s24
    s_mul_i32 s38, s38, 81920
    s_add_u32 s41, s41, s38
    s_add_u32 s42, s42, s38
    s_mov_b32 s30, -1
    s_mov_b32 s31, 0
    s_waitcnt lgkmcnt(0)
    s_mov_b32 s8, s4
    s_mov_b32 s9, s5
    s_mov_b32 s10, 5242880
    s_mov_b32 s11, 0x00020000
    buffer_load_dwordx4 v[100:103], v0, s[8:11], s25 offen
    buffer_load_dwordx4 v[76:79], v0, s[8:11], s41 offen
    s_mov_b64 exec, s[30:31]
    buffer_load_dwordx2 v[108:109], v0, s[8:11], s26 offen
    buffer_load_dwordx2 v[92:93], v0, s[8:11], s42 offen
    s_mov_b64 exec, -1
    s_mov_b32 s35, s25
    s_mov_b32 s36, s26
    s_add_u32 s25, s25, 81920
    s_add_u32 s26, s26, 81920
    buffer_load_dwordx4 v[104:107], v0, s[8:11], s25 offen
    s_mov_b64 exec, s[30:31]
    buffer_load_dwordx2 v[110:111], v0, s[8:11], s26 offen
    s_mov_b64 exec, -1
    s_mov_b32 s32, 0xfffff
    s_mov_b32 s33, 0xfffff
    s_mov_b32 s44, 0x100000
    s_mov_b32 s45, 0x100000
    s_mov_b32 s34, 0
    s_movk_i32 s46, 20480
    s_mov_b32 s47, 40960
    s_mov_b32 s48, 81920
    v_mov_b32 v2, 0x3f803f80
    s_not_b64 exec, s[30:31]
    v_mov_b32 v92, 0
    v_mov_b32 v93, 0
    v_mov_b32 v108, v2
    v_mov_b32 v109, 0x3f80
    v_mov_b32 v110, v2
    v_mov_b32 v111, 0x3f80
    s_not_b64 exec, s[32:33]
    v_cndmask_b32 v112, 0, v2, s[44:45]
    v_cndmask_b32 v113, 0, v2, s[44:45]
    v_cndmask_b32 v114, 0, v2, s[44:45]
    v_cndmask_b32 v115, 0, v2, s[44:45]
    v_cndmask_b32 v116, 0, v2, s[44:45]
    v_cndmask_b32 v117, 0, v2, s[44:45]
    v_cndmask_b32 v118, 0, v2, s[44:45]
    v_cndmask_b32 v119, 0, v2, s[44:45]
    s_mov_b64 exec, -1
    v_cndmask_b32 v120, 0, v2, s[44:45]
    v_cndmask_b32 v121, 0, v2, s[44:45]
    v_cndmask_b32 v122, 0, v2, s[44:45]
    v_cndmask_b32 v123, 0, v2, s[44:45]
    v_cndmask_b32 v124, 0, v2, s[44:45]
    v_cndmask_b32 v125, 0, v2, s[44:45]
    v_cndmask_b32 v126, 0, v2, s[44:45]
    v_cndmask_b32 v127, 0, v2, s[44:45]
    s_mul_i32 s37, s21, 320
    v_lshrrev_b32 v2, 5, v5
    v_mul_u32_u24 v2, 10240, v2
    v_and_b32 v3, 31, v5
    v_lshl_add_u32 v1, v3, 4, v2
    s_mul_i32 s38, s24, 655360
    s_add_u32 s37, s37, s38
    s_mov_b32 s27, s37
    s_add_u32 s29, s37, 20480
    s_add_u32 s12, s4, 5242880
    s_addc_u32 s13, s5, 0
    s_mov_b32 s14, 2621440
    s_mov_b32 s15, 0x00020000
    s_mov_b64 exec, s[32:33]
    buffer_load_dwordx4 v[112:115], v1, s[12:15], s27 offen
    buffer_load_dwordx4 v[116:119], v1, s[12:15], s29 offen
    s_mov_b64 exec, -1
    s_barrier
    s_add_u32 s27, s27, 40960
    s_add_u32 s29, s29, 40960
    s_add_u32 s16, s4, 14942208
    s_addc_u32 s17, s5, 0
    s_mov_b32 s18, 2621440
    s_mov_b32 s19, 0x00020000
    v_mov_b32 v2, 135168
    v_mov_b32 v3, 0
    ds_write2_b32 v2, v3, v3 offset1:1
    ds_write_b32 v2, v3 offset:8
    s_mul_i32 s39, s23, 36864
    s_add_u32 s38, s24, 1
    s_and_b32 s38, s38, 3
    s_mul_i32 s38, s38, 9216
    s_add_u32 s38, s38, s39
    v_add_u32 v6, s38, v0
    s_add_u32 s38, s24, 2
    s_and_b32 s38, s38, 3
    s_mul_i32 s38, s38, 9216
    s_add_u32 s38, s38, s39
    v_add_u32 v7, s38, v0
    s_add_u32 s38, s24, 3
    s_and_b32 s38, s38, 3
    s_mul_i32 s38, s38, 9216
    s_add_u32 s38, s38, s39
    v_add_u32 v8, s38, v0
    s_mul_i32 s38, s24, 9216
    s_add_u32 s38, s38, s39
    v_add_u32 v9, s38, v0
    v_and_b32 v3, 0x100, v0
    v_mul_u32_u24 v3, 80, v3
    v_lshrrev_b32 v4, 9, v0
    v_lshl_add_u32 v3, v4, 8, v3
    v_and_b32 v4, 0xf0, v0
    v_add_u32 v5, v3, v4
    s_lshl_b32 s38, s22, 3
    s_lshl_b32 s39, s23, 2
    s_add_u32 s38, s38, s39
    s_add_u32 s38, s38, s24
    s_mul_i32 s38, s38, 40960
    s_lshl_b32 s49, s21, 9
    s_add_u32 s49, s49, s38
    s_lshr_b32 s39, s21, 3
    s_lshl_b32 s39, s39, 10
    s_add_u32 s38, s38, s39
    s_and_b32 s39, s21, 7
    s_lshl_b32 s39, s39, 7
    s_add_u32 s38, s38, s39
    s_add_u32 s50, s38, 16384
    s_mul_i32 s39, s23, 6144
    s_add_u32 s39, s39, 135232
    v_lshrrev_b32 v4, 1, v0
    s_add_u32 s38, s24, 0
    s_and_b32 s38, s38, 3
    s_mul_i32 s38, s38, 1536
    s_add_u32 s38, s38, s39
    v_add_u32 v152, s38, v0
    v_add_u32 v153, s38, v4
    s_add_u32 s38, s24, 1
    s_and_b32 s38, s38, 3
    s_mul_i32 s38, s38, 1536
    s_add_u32 s38, s38, s39
    v_add_u32 v154, s38, v0
    v_add_u32 v155, s38, v4
    s_add_u32 s38, s24, 2
    s_and_b32 s38, s38, 3
    s_mul_i32 s38, s38, 1536
    s_add_u32 s38, s38, s39
    v_add_u32 v156, s38, v0
    v_add_u32 v157, s38, v4
    s_add_u32 s38, s24, 3
    s_and_b32 s38, s38, 3
    s_mul_i32 s38, s38, 1536
    s_add_u32 s38, s38, s39
    v_add_u32 v158, s38, v0
    v_add_u32 v159, s38, v4
    s_and_b32 s78, s20, 3
    s_and_b32 s80, s20, 1
    s_bfe_u32 s79, s20, 0x10001
    s_mul_i32 s77, s78, 163840
    s_mul_i32 s86, s78, 122880
    s_sub_u32 s86, 655360, s86
    s_bfe_u32 s38, s2, 0x20003
    s_mul_i32 s38, s38, 10240
    s_add_u32 s77, s77, s38
    s_add_u32 s77, s77, 2211840
    s_movk_i32 s85, 15360
    s_add_u32 s56, s4, 17563648
    s_addc_u32 s57, s5, 0
    s_mov_b32 s58, 3031040
    s_mov_b32 s59, 0x00020000
    s_lshl_b32 s38, s80, 11
    s_lshl_b32 s39, s80, 10
    s_xor_b32 s40, s39, 1024
    s_cmp_lt_u32 s20, 4
    s_movk_i32 s72, 0x3f0
    s_cmovk_i32 s72, 0x330
    s_cselect_b32 s73, 64, 0
    s_cselect_b32 s74, 0x80, 0
    s_cselect_b32 s75, 0, s39
    s_cselect_b32 s76, 64, s40
    s_cselect_b32 s38, s38, 4096
    s_add_u32 s77, s77, s38
    v_and_b32 v2, s72, v0
    v_and_b32 v3, s73, v0
    v_and_b32 v160, s74, v0
    v_lshl_or_b32 v2, v3, 1, v2
    v_lshl_or_b32 v2, v160, 3, v2
    v_add_u32 v3, s76, v2
    v_add_u32 v2, s75, v2
    v_mov_b32 v160, 0
    v_mov_b32 v161, 0
    v_mov_b32 v162, 0
    v_mov_b32 v163, 0
    s_waitcnt vmcnt(4)
    v_mfma_f32_32x32x16_bf16 v[12:27], v[100:103], v[76:79], 0
    v_mfma_f32_32x32x8_bf16 v[12:27], v[108:109], v[92:93], v[12:27]
    ds_write_b128 v152, v[76:79]
    v_mfma_f32_32x32x16_bf16 v[28:43], v[160:163], v[160:163], 0
    v_mfma_f32_32x32x16_bf16 v[44:59], v[160:163], v[160:163], 0
    v_mfma_f32_32x32x16_bf16 v[60:75], v[160:163], v[160:163], 0
    s_waitcnt vmcnt(2)
    v_mfma_f32_32x32x16_bf16 v[128:143], v[104:107], v[76:79], 0
    v_mfma_f32_32x32x8_bf16 v[128:143], v[110:111], v[92:93], v[128:143]
    s_nop 4
    v_max3_f32 v164, v12, v13, v14
    v_max_f32 v164, v164, v15
    v_max3_f32 v164, v164, v16, v17
    v_max3_f32 v164, v164, v18, v19
    v_max3_f32 v164, v164, v20, v21
    v_max3_f32 v164, v164, v22, v23
    v_max3_f32 v164, v164, v24, v25
    v_max3_f32 v164, v164, v26, v27
    v_max3_f32 v164, v164, v128, v129
    v_max3_f32 v164, v164, v130, v131
    v_max3_f32 v164, v164, v132, v133
    v_max3_f32 v164, v164, v134, v135
    v_max3_f32 v164, v164, v136, v137
    v_max3_f32 v164, v164, v138, v139
    v_max3_f32 v164, v164, v140, v141
    v_max3_f32 v164, v164, v142, v143
    v_mov_b32 v144, v164
    s_nop 1
    v_permlane32_swap_b32 v164, v144
    s_nop 0
    v_max_f32 v164, v164, v144
    v_sub_f32 v164, 0xc2c00000, v164
    v_and_b32 v144, 0xffff0000, v164
    v_sub_f32 v164, v164, v144
    v_and_b32 v148, 0xffff0000, v164
    v_sub_f32 v164, v164, v148
    v_lshrrev_b32 v144, 16, v144
    v_or_b32 v144, v144, v148
    v_lshrrev_b32 v164, 16, v164
    v_cndmask_b32 v92, v144, v92, s[30:31]
    v_cndmask_b32 v93, v164, v93, s[30:31]
    ds_write_b64 v153, v[92:93] offset:1024
    v_mov_b32 v164, 0
    v_mov_b32 v165, 0
    v_mov_b32 v166, 0
    v_mov_b32 v167, 0
    s_add_u32 s25, s25, 81920
    s_add_u32 s26, s26, 81920
    s_waitcnt vmcnt(4)
    v_mfma_f32_32x32x16_bf16 v[128:143], v[100:103], v[76:79], 0
    v_mfma_f32_32x32x8_bf16 v[128:143], v[108:109], v[92:93], v[128:143]
    v_mfma_f32_32x32x16_bf16 v[12:27], v[160:163], v[160:163], 0
    s_waitcnt vmcnt(0) lgkmcnt(0)
    s_setprio 0
    s_cmp_lt_u32 s20, 4
    s_cbranch_scc1 k2_old
    s_setprio 1
k2_old:
    s_barrier
    ds_read_b128 v[80:83], v154
    ds_read_b64 v[94:95], v155 offset:1024
    ds_read_b128 v[84:87], v156
    ds_read_b64 v[96:97], v157 offset:1024
    ds_read_b128 v[88:91], v158
    ds_read_b64 v[98:99], v159 offset:1024
    s_waitcnt lgkmcnt(0)
    s_branch k2_go
k2_run:
    v_mov_b32 v160, 0
    v_mov_b32 v161, 0
    v_mov_b32 v162, 0
    v_mov_b32 v163, 0
    v_mov_b32 v164, 0
    v_mov_b32 v165, 0
    v_mov_b32 v166, 0
    v_mov_b32 v167, 0
    s_add_u32 s25, s25, 81920
    s_add_u32 s26, s26, 81920
    s_waitcnt vmcnt(4)
    v_mfma_f32_32x32x16_bf16 v[128:143], v[100:103], v[76:79], 0
    v_mfma_f32_32x32x8_bf16 v[128:143], v[108:109], v[92:93], v[128:143]
    v_mfma_f32_32x32x16_bf16 v[12:27], v[160:163], v[160:163], 0
    v_mfma_f32_32x32x16_bf16 v[28:43], v[160:163], v[160:163], 0
    v_mfma_f32_32x32x16_bf16 v[44:59], v[160:163], v[160:163], 0
    v_mfma_f32_32x32x16_bf16 v[60:75], v[160:163], v[160:163], 0
    s_nop 6
k2_go:
    v_mov_b32 v4, 0xdddddddd
    s_mov_b32 s28, 8
.p2align 6
k2_loop:
    v_mfma_f32_32x32x16_bf16 v[144:159], v[100:103], v[80:83], 0
    v_exp_f32 v128, v128
    v_exp_f32 v129, v129
    v_exp_f32 v130, v130
    v_exp_f32 v131, v131
    v_smfmac_f32_32x32x32_bf16 v[60:75], v[124:127], v[160:167], v4
    v_exp_f32 v132, v132
    v_exp_f32 v133, v133
    v_exp_f32 v134, v134
    v_exp_f32 v135, v135
    v_mfma_f32_32x32x8_bf16 v[144:159], v[108:109], v[94:95], v[144:159]
    s_mov_b64 exec, s[32:33]
    s_add_u32 s29, s27, s46
    buffer_load_dwordx4 v[120:123], v1, s[12:15], s27 offen
    buffer_load_dwordx4 v[124:127], v1, s[12:15], s29 offen
    s_mov_b64 exec, -1
    s_add_u32 s27, s27, s47
    v_exp_f32 v160, v136
    v_exp_f32 v161, v137
    v_exp_f32_e64 v162, v138
    v_exp_f32 v163, v139
    s_waitcnt vmcnt(4)
    v_smfmac_f32_32x32x32_bf16 v[12:27], v[112:115], v[128:135], v4
    v_exp_f32 v164, v140
    v_exp_f32 v165, v141
    v_exp_f32 v166, v142
    v_exp_f32 v167, v143
    v_mfma_f32_32x32x16_bf16 v[128:143], v[100:103], v[84:87], 0
    v_exp_f32 v144, v144
    v_exp_f32 v145, v145
    v_exp_f32 v146, v146
    v_exp_f32 v147, v147
    v_smfmac_f32_32x32x32_bf16 v[12:27], v[116:119], v[160:167], v4
    v_exp_f32 v148, v148
    v_exp_f32 v149, v149
    v_exp_f32 v150, v150
    v_exp_f32 v151, v151
    v_mfma_f32_32x32x8_bf16 v[128:143], v[108:109], v[96:97], v[128:143]
    v_exp_f32 v160, v152
    v_exp_f32 v161, v153
    v_exp_f32 v162, v154
    v_exp_f32 v163, v155
    v_smfmac_f32_32x32x32_bf16 v[28:43], v[112:115], v[144:151], v4
    v_exp_f32 v164, v156
    v_exp_f32 v165, v157
    v_exp_f32_e64 v166, v158
    v_exp_f32 v167, v159
    s_nop 1
    v_mfma_f32_32x32x16_bf16 v[144:159], v[100:103], v[88:91], 0
    v_exp_f32 v128, v128
    v_exp_f32 v129, v129
    v_exp_f32 v130, v130
    v_exp_f32 v131, v131
    v_smfmac_f32_32x32x32_bf16 v[28:43], v[116:119], v[160:167], v4
    v_exp_f32 v132, v132
    v_exp_f32 v133, v133
    v_exp_f32 v134, v134
    v_exp_f32 v135, v135
    v_mfma_f32_32x32x8_bf16 v[144:159], v[108:109], v[98:99], v[144:159]
    v_exp_f32 v160, v136
    v_exp_f32 v161, v137
    v_exp_f32 v162, v138
    v_exp_f32 v163, v139
    v_smfmac_f32_32x32x32_bf16 v[44:59], v[112:115], v[128:135], v4
    v_exp_f32 v164, v140
    v_exp_f32 v165, v141
    v_exp_f32 v166, v142
    v_exp_f32 v167, v143
    s_nop 0
    s_waitcnt vmcnt(2)
    v_mfma_f32_32x32x16_bf16 v[128:143], v[104:107], v[76:79], 0
    v_exp_f32 v144, v144
    v_exp_f32 v145, v145
    v_exp_f32 v146, v146
    v_exp_f32 v147, v147
    v_smfmac_f32_32x32x32_bf16 v[44:59], v[116:119], v[160:167], v4
    v_exp_f32 v148, v148
    v_exp_f32 v149, v149
    v_exp_f32 v150, v150
    v_exp_f32 v151, v151
    v_mfma_f32_32x32x8_bf16 v[128:143], v[110:111], v[92:93], v[128:143]
    buffer_load_dwordx4 v[100:103], v0, s[8:11], s25 offen
    s_mov_b64 exec, s[30:31]
    s_add_u32 s25, s25, s48
    buffer_load_dwordx2 v[108:109], v0, s[8:11], s26 offen
    s_mov_b64 exec, -1
    s_add_u32 s26, s26, s48
    v_exp_f32 v160, v152
    v_exp_f32 v161, v153
    v_exp_f32 v162, v154
    v_exp_f32 v163, v155
    v_smfmac_f32_32x32x32_bf16 v[60:75], v[112:115], v[144:151], v4
    v_exp_f32 v164, v156
    v_exp_f32 v165, v157
    v_exp_f32 v166, v158
    v_exp_f32 v167, v159
    v_mfma_f32_32x32x16_bf16 v[144:159], v[104:107], v[80:83], 0
    v_exp_f32 v128, v128
    v_exp_f32 v129, v129
    v_exp_f32 v130, v130
    v_exp_f32 v131, v131
    v_smfmac_f32_32x32x32_bf16 v[60:75], v[116:119], v[160:167], v4
    v_exp_f32 v132, v132
    v_exp_f32 v133, v133
    v_exp_f32 v134, v134
    v_exp_f32 v135, v135
    v_mfma_f32_32x32x8_bf16 v[144:159], v[110:111], v[94:95], v[144:159]
    s_mov_b64 exec, s[32:33]
    s_add_u32 s29, s27, s46
    buffer_load_dwordx4 v[112:115], v1, s[12:15], s27 offen
    buffer_load_dwordx4 v[116:119], v1, s[12:15], s29 offen
    s_mov_b64 exec, -1
    s_add_u32 s27, s27, s47
    v_exp_f32 v160, v136
    v_exp_f32 v161, v137
    v_exp_f32_e64 v162, v138
    v_exp_f32 v163, v139
    s_waitcnt vmcnt(4)
    v_smfmac_f32_32x32x32_bf16 v[12:27], v[120:123], v[128:135], v4
    v_exp_f32 v164, v140
    v_exp_f32 v165, v141
    v_exp_f32 v166, v142
    v_exp_f32 v167, v143
    v_mfma_f32_32x32x16_bf16 v[128:143], v[104:107], v[84:87], 0
    v_exp_f32 v144, v144
    v_exp_f32 v145, v145
    v_exp_f32 v146, v146
    v_exp_f32 v147, v147
    v_smfmac_f32_32x32x32_bf16 v[12:27], v[124:127], v[160:167], v4
    v_exp_f32 v148, v148
    v_exp_f32 v149, v149
    v_exp_f32 v150, v150
    v_exp_f32 v151, v151
    v_mfma_f32_32x32x8_bf16 v[128:143], v[110:111], v[96:97], v[128:143]
    v_exp_f32 v160, v152
    v_exp_f32 v161, v153
    v_exp_f32 v162, v154
    v_exp_f32 v163, v155
    v_smfmac_f32_32x32x32_bf16 v[28:43], v[120:123], v[144:151], v4
    v_exp_f32 v164, v156
    v_exp_f32 v165, v157
    v_exp_f32_e64 v166, v158
    v_exp_f32 v167, v159
    s_nop 1
    v_mfma_f32_32x32x16_bf16 v[144:159], v[104:107], v[88:91], 0
    v_exp_f32 v128, v128
    v_exp_f32 v129, v129
    v_exp_f32 v130, v130
    v_exp_f32 v131, v131
    v_smfmac_f32_32x32x32_bf16 v[28:43], v[124:127], v[160:167], v4
    v_exp_f32 v132, v132
    v_exp_f32 v133, v133
    v_exp_f32 v134, v134
    v_exp_f32 v135, v135
    v_mfma_f32_32x32x8_bf16 v[144:159], v[110:111], v[98:99], v[144:159]
    v_exp_f32 v160, v136
    v_exp_f32 v161, v137
    v_exp_f32 v162, v138
    v_exp_f32 v163, v139
    v_smfmac_f32_32x32x32_bf16 v[44:59], v[120:123], v[128:135], v4
    v_exp_f32 v164, v140
    v_exp_f32 v165, v141
    v_exp_f32 v166, v142
    v_exp_f32 v167, v143
    s_nop 1
    s_waitcnt vmcnt(2)
    s_cmp_lg_u32 s28, 3
    s_cbranch_scc1 k2_nosw
    s_setprio 0
    s_nop 0
k2_nosw:
    v_mfma_f32_32x32x16_bf16 v[128:143], v[100:103], v[76:79], 0
    v_exp_f32 v144, v144
    v_exp_f32 v145, v145
    v_exp_f32 v146, v146
    v_exp_f32 v147, v147
    v_smfmac_f32_32x32x32_bf16 v[44:59], v[124:127], v[160:167], v4
    v_exp_f32 v148, v148
    v_exp_f32 v149, v149
    v_exp_f32 v150, v150
    v_exp_f32 v151, v151
    v_mfma_f32_32x32x8_bf16 v[128:143], v[108:109], v[92:93], v[128:143]
    buffer_load_dwordx4 v[104:107], v0, s[8:11], s25 offen
    s_mov_b64 exec, s[30:31]
    s_add_u32 s25, s25, s48
    buffer_load_dwordx2 v[110:111], v0, s[8:11], s26 offen
    s_mov_b64 exec, -1
    s_add_u32 s26, s26, s48
    v_exp_f32 v160, v152
    v_exp_f32 v161, v153
    v_exp_f32 v162, v154
    v_exp_f32 v163, v155
    v_smfmac_f32_32x32x32_bf16 v[60:75], v[120:123], v[144:151], v4
    v_exp_f32 v164, v156
    v_exp_f32 v165, v157
    v_exp_f32 v166, v158
    v_exp_f32 v167, v159
    s_sub_u32 s28, s28, 1
    s_cmp_lg_u32 s28, 1
    s_cbranch_scc1 k2_loop
    s_nop 0
k2_tail:
    v_mfma_f32_32x32x16_bf16 v[144:159], v[100:103], v[80:83], 0
    v_exp_f32 v128, v128
    v_exp_f32 v129, v129
    v_exp_f32 v130, v130
    v_exp_f32 v131, v131
    v_smfmac_f32_32x32x32_bf16 v[60:75], v[124:127], v[160:167], v4
    v_exp_f32 v132, v132
    v_exp_f32 v133, v133
    v_exp_f32 v134, v134
    v_exp_f32 v135, v135
    v_mfma_f32_32x32x8_bf16 v[144:159], v[108:109], v[94:95], v[144:159]
    s_mov_b64 exec, s[32:33]
    s_add_u32 s29, s27, s46
    buffer_load_dwordx4 v[120:123], v1, s[12:15], s27 offen
    buffer_load_dwordx4 v[124:127], v1, s[12:15], s29 offen
    s_mov_b64 exec, -1
    s_add_u32 s27, s27, s47
    v_exp_f32 v160, v136
    v_exp_f32 v161, v137
    v_exp_f32_e64 v162, v138
    v_exp_f32 v163, v139
    s_waitcnt vmcnt(4)
    v_smfmac_f32_32x32x32_bf16 v[12:27], v[112:115], v[128:135], v4
    v_exp_f32 v164, v140
    v_exp_f32 v165, v141
    v_exp_f32 v166, v142
    v_exp_f32 v167, v143
    v_mfma_f32_32x32x16_bf16 v[128:143], v[100:103], v[84:87], 0
    v_exp_f32 v144, v144
    v_exp_f32 v145, v145
    v_exp_f32 v146, v146
    v_exp_f32 v147, v147
    v_smfmac_f32_32x32x32_bf16 v[12:27], v[116:119], v[160:167], v4
    v_exp_f32 v148, v148
    v_exp_f32 v149, v149
    v_exp_f32 v150, v150
    v_exp_f32 v151, v151
    v_mfma_f32_32x32x8_bf16 v[128:143], v[108:109], v[96:97], v[128:143]
    v_exp_f32 v160, v152
    v_exp_f32 v161, v153
    v_exp_f32 v162, v154
    v_exp_f32 v163, v155
    v_smfmac_f32_32x32x32_bf16 v[28:43], v[112:115], v[144:151], v4
    v_exp_f32 v164, v156
    v_exp_f32 v165, v157
    v_exp_f32_e64 v166, v158
    v_exp_f32 v167, v159
    s_nop 1
    v_mfma_f32_32x32x16_bf16 v[144:159], v[100:103], v[88:91], 0
    v_exp_f32 v128, v128
    v_exp_f32 v129, v129
    v_exp_f32 v130, v130
    v_exp_f32 v131, v131
    v_smfmac_f32_32x32x32_bf16 v[28:43], v[116:119], v[160:167], v4
    v_exp_f32 v132, v132
    v_exp_f32 v133, v133
    v_exp_f32 v134, v134
    v_exp_f32 v135, v135
    v_mfma_f32_32x32x8_bf16 v[144:159], v[108:109], v[98:99], v[144:159]
    v_exp_f32 v160, v136
    v_exp_f32 v161, v137
    v_exp_f32 v162, v138
    v_exp_f32 v163, v139
    v_smfmac_f32_32x32x32_bf16 v[44:59], v[112:115], v[128:135], v4
    v_exp_f32 v164, v140
    v_exp_f32 v165, v141
    v_exp_f32 v166, v142
    v_exp_f32 v167, v143
    s_nop 0
    s_waitcnt vmcnt(2)
    v_mfma_f32_32x32x16_bf16 v[128:143], v[104:107], v[80:83], 0
    v_exp_f32 v144, v144
    v_exp_f32 v145, v145
    v_exp_f32 v146, v146
    v_exp_f32 v147, v147
    v_smfmac_f32_32x32x32_bf16 v[44:59], v[116:119], v[160:167], v4
    v_exp_f32 v148, v148
    v_exp_f32 v149, v149
    v_exp_f32 v150, v150
    v_exp_f32 v151, v151
    v_mfma_f32_32x32x8_bf16 v[128:143], v[110:111], v[94:95], v[128:143]
    v_exp_f32 v160, v152
    v_exp_f32 v161, v153
    v_exp_f32 v162, v154
    v_exp_f32 v163, v155
    v_smfmac_f32_32x32x32_bf16 v[60:75], v[112:115], v[144:151], v4
    v_exp_f32 v164, v156
    v_exp_f32 v165, v157
    v_exp_f32_e64 v166, v158
    v_exp_f32 v167, v159
    s_nop 1
    v_mfma_f32_32x32x16_bf16 v[144:159], v[104:107], v[84:87], 0
    v_exp_f32 v128, v128
    v_exp_f32 v129, v129
    v_exp_f32 v130, v130
    v_exp_f32 v131, v131
    v_smfmac_f32_32x32x32_bf16 v[60:75], v[116:119], v[160:167], v4
    v_exp_f32 v132, v132
    v_exp_f32 v133, v133
    v_exp_f32 v134, v134
    v_exp_f32 v135, v135
    v_mfma_f32_32x32x8_bf16 v[144:159], v[110:111], v[96:97], v[144:159]
    s_waitcnt vmcnt(0)
    s_nop 0
    s_add_u32 s83, s77, 122880
    buffer_load_dwordx4 v[100:103], v2, s[56:59], s83 offen
    s_add_u32 s83, s77, 0
    s_nop 0
    buffer_load_dwordx4 v[80:83], v3, s[56:59], s83 offen
    s_add_u32 s83, s77, s86
    s_nop 0
    buffer_load_dwordx4 v[112:115], v3, s[56:59], s83 offen
    v_exp_f32 v160, v136
    v_exp_f32 v161, v137
    v_exp_f32 v162, v138
    v_exp_f32 v163, v139
    v_smfmac_f32_32x32x32_bf16 v[28:43], v[120:123], v[128:135], v4
    v_exp_f32 v164, v140
    v_exp_f32 v165, v141
    v_exp_f32_e64 v166, v142
    v_exp_f32 v167, v143
    s_nop 1
    v_mfma_f32_32x32x16_bf16 v[128:143], v[104:107], v[88:91], 0
    v_exp_f32 v144, v144
    v_exp_f32 v145, v145
    v_exp_f32 v146, v146
    v_exp_f32 v147, v147
    v_smfmac_f32_32x32x32_bf16 v[28:43], v[124:127], v[160:167], v4
    v_exp_f32 v148, v148
    v_exp_f32 v149, v149
    v_exp_f32 v150, v150
    v_exp_f32 v151, v151
    v_mfma_f32_32x32x8_bf16 v[128:143], v[110:111], v[98:99], v[128:143]
    s_add_u32 s83, s77, 40960
    buffer_load_dwordx4 v[84:87], v2, s[56:59], s83 offen
    v_exp_f32 v160, v152
    v_exp_f32 v161, v153
    v_exp_f32 v162, v154
    v_exp_f32 v163, v155
    v_smfmac_f32_32x32x32_bf16 v[44:59], v[120:123], v[144:151], v4
    v_exp_f32 v164, v156
    v_exp_f32 v165, v157
    v_exp_f32 v166, v158
    v_exp_f32 v167, v159
    ds_write_b128 v6, v[28:31] offset:0
    ds_write_b128 v6, v[32:35] offset:1024
    ds_write_b128 v6, v[36:39] offset:2048
    v_mfma_f32_32x32x16_bf16 v[144:159], v[104:107], v[76:79], 0
    v_exp_f32 v128, v128
    v_exp_f32 v129, v129
    v_exp_f32 v130, v130
    v_exp_f32 v131, v131
    v_smfmac_f32_32x32x32_bf16 v[44:59], v[124:127], v[160:167], v4
    v_exp_f32 v132, v132
    v_exp_f32 v133, v133
    v_exp_f32 v134, v134
    v_exp_f32 v135, v135
    v_mfma_f32_32x32x8_bf16 v[144:159], v[110:111], v[92:93], v[144:159]
    s_add_u32 s83, s77, 40960
    buffer_load_dwordx4 v[88:91], v3, s[56:59], s83 offen
    s_add_u32 s83, s77, 81920
    buffer_load_dwordx4 v[96:99], v3, s[56:59], s83 offen
    v_exp_f32 v160, v136
    v_exp_f32 v161, v137
    v_exp_f32 v162, v138
    v_exp_f32 v163, v139
    v_smfmac_f32_32x32x32_bf16 v[60:75], v[120:123], v[128:135], v4
    v_exp_f32 v164, v140
    v_exp_f32 v165, v141
    v_exp_f32 v166, v142
    v_exp_f32 v167, v143
    ds_write_b128 v7, v[44:47] offset:3072
    ds_write_b128 v7, v[48:51] offset:4096
    ds_write_b128 v7, v[52:55] offset:5120
    v_exp_f32 v144, v144
    v_exp_f32 v145, v145
    v_smfmac_f32_32x32x32_bf16 v[60:75], v[124:127], v[160:167], v4
    s_add_u32 s83, s77, 0
    s_nop 0
    buffer_load_dwordx4 v[76:79], v2, s[56:59], s83 offen
    s_add_u32 s83, s77, 81920
    buffer_load_dwordx4 v[92:95], v2, s[56:59], s83 offen
    s_add_u32 s83, s77, 122880
    buffer_load_dwordx4 v[104:107], v3, s[56:59], s83 offen
    s_add_u32 s83, s77, s86
    s_nop 0
    buffer_load_dwordx4 v[108:111], v2, s[56:59], s83 offen
    v_exp_f32 v146, v146
    v_exp_f32 v147, v147
    s_waitcnt lgkmcnt(0)
    s_barrier
    ds_read_b128 v[36:39], v9 offset:2048
    ds_read_b128 v[28:31], v9 offset:0
    ds_read_b128 v[32:35], v9 offset:1024
    ds_read_b128 v[52:55], v9 offset:5120
    ds_read_b128 v[44:47], v9 offset:3072
    ds_read_b128 v[48:51], v9 offset:4096
    v_exp_f32 v148, v148
    v_exp_f32 v149, v149
    v_exp_f32 v150, v150
    v_exp_f32 v151, v151
    v_exp_f32 v160, v152
    v_exp_f32 v161, v153
    v_exp_f32 v162, v154
    v_exp_f32 v163, v155
    v_smfmac_f32_32x32x32_bf16 v[12:27], v[120:123], v[144:151], v4
    ds_write_b128 v8, v[60:63] offset:6144
    ds_write_b128 v8, v[64:67] offset:7168
    ds_write_b128 v8, v[68:71] offset:8192
    v_exp_f32 v164, v156
    v_exp_f32 v165, v157
    v_exp_f32 v166, v158
    v_exp_f32 v167, v159
    v_bfe_u32 v128, v0, 4, 4
    v_lshlrev_b32_e64 v128, 3, v128
    v_smfmac_f32_32x32x32_bf16 v[12:27], v[124:127], v[160:167], v4
    s_waitcnt lgkmcnt(0)
    s_barrier
    ds_read_b128 v[68:71], v9 offset:8192
    ds_read_b128 v[60:63], v9 offset:6144
    ds_read_b128 v[64:67], v9 offset:7168
    v_pk_add_f32 v[36:37], v[36:37], v[52:53]
    v_pk_add_f32 v[38:39], v[38:39], v[54:55]
    v_pk_add_f32 v[28:29], v[28:29], v[44:45]
    v_pk_add_f32 v[30:31], v[30:31], v[46:47]
    v_pk_add_f32 v[32:33], v[32:33], v[48:49]
    v_pk_add_f32 v[34:35], v[34:35], v[50:51]
    v_sub_u32 v158, v5, v128
    v_mov_b32 v131, 135168
    v_pk_add_f32 v[20:21], v[20:21], v[36:37]
    v_pk_add_f32 v[22:23], v[22:23], v[38:39]
    v_pk_add_f32 v[12:13], v[12:13], v[28:29]
    v_pk_add_f32 v[14:15], v[14:15], v[30:31]
    v_pk_add_f32 v[16:17], v[16:17], v[32:33]
    v_pk_add_f32 v[18:19], v[18:19], v[34:35]
    s_waitcnt lgkmcnt(2)
    v_pk_add_f32 v[20:21], v[20:21], v[68:69]
    v_pk_add_f32 v[22:23], v[22:23], v[70:71]
    v_mov_b32 v128, v20
    v_mov_b32 v129, v20
    s_waitcnt lgkmcnt(1)
    v_pk_add_f32 v[12:13], v[12:13], v[60:61]
    v_pk_add_f32 v[14:15], v[14:15], v[62:63]
    v_permlane32_swap_b32 v128, v129
    s_waitcnt lgkmcnt(0)
    v_pk_mul_f32 v[132:133], v[20:21], 0
    v_rcp_f32 v130, v129
    v_pk_add_f32 v[16:17], v[16:17], v[64:65]
    v_pk_add_f32 v[18:19], v[18:19], v[66:67]
    v_pk_fma_f32 v[132:133], v[22:23], 0, v[132:133]
    v_pk_mul_f32 v[38:39], v[22:23], v[130:131] op_sel_hi:[1,0]
    v_pk_fma_f32 v[132:133], v[12:13], 0, v[132:133]
    v_pk_mul_f32 v[28:29], v[12:13], v[130:131] op_sel_hi:[1,0]
    v_pk_fma_f32 v[132:133], v[14:15], 0, v[132:133]
    v_pk_mul_f32 v[30:31], v[14:15], v[130:131] op_sel_hi:[1,0]
    v_pk_fma_f32 v[132:133], v[16:17], 0, v[132:133]
    v_pk_mul_f32 v[32:33], v[16:17], v[130:131] op_sel_hi:[1,0]
    v_pk_fma_f32 v[132:133], v[18:19], 0, v[132:133]
    v_pk_mul_f32 v[34:35], v[18:19], v[130:131] op_sel_hi:[1,0]
    v_pk_mul_f32 v[36:37], v[20:21], v[130:131] op_sel_hi:[1,0]
    v_add_f32 v132, v132, v133
    v_cvt_pk_bf16_f32 v160, v28, v29
    v_add_f32 v132, v132, v129
    v_cvt_pk_bf16_f32 v161, v30, v31
    v_cmp_nge_f32 vcc, 0x7b800000, v132
    v_cvt_pk_bf16_f32 v162, v32, v33
    v_cvt_pk_bf16_f32 v163, v34, v35
    v_cvt_pk_bf16_f32 v164, v36, v37
    v_cvt_pk_bf16_f32 v165, v38, v39
    s_cmp_lg_u32 s34, 0
    s_cbranch_scc1 k2_second
    s_cbranch_vccnz k2_bad
k2_store:
    buffer_store_dwordx4 v[160:163], v5, s[16:19], s49 offen sc1
    s_mov_b64 exec, s[30:31]
    buffer_store_dwordx2 v[164:165], v158, s[16:19], s50 offen sc1
    s_mov_b64 exec, -1
k2_okw:
    s_barrier
    ds_read_b32 v128, v131
    v_and_b32 v158, 0xf0, v0
    v_lshrrev_b32 v159, 8, v0
    s_waitcnt lgkmcnt(0)
    v_readfirstlane_b32 s38, v128
    s_cmp_gt_u32 s38, s34
    s_cbranch_scc1 k2_fb
    s_mul_i32 s39, s78, 10240
    s_mul_i32 s40, s79, 5120
    s_add_u32 s72, s39, s40
    s_sub_u32 s73, s39, s40
    s_add_u32 s73, s73, 5120
    s_mov_b32 s60, s64
    s_mov_b32 s61, s65
    s_mov_b32 s62, 2621440
    s_mov_b32 s63, 0x00020000
    s_movk_i32 s81, 0x3ff
    s_movk_i32 s82, 64
    s_cmp_lt_u32 s20, 4
    s_cbranch_scc0 k2_pb
    s_lshl_b32 s38, s80, 10
    s_lshl_b32 s39, s79, 8
    s_add_u32 s38, s38, s39
    s_add_u32 s38, s38, 73728
    v_add_u32 v4, s38, v158
    v_mad_u32_u24 v4, v159, s85, v4
    s_mul_i32 s38, s78, 15360
    s_add_u32 s38, s38, 78848
    v_add_u32 v5, s38, v0
    ds_read_b128 v[12:15], v4 offset:0
    ds_read_b128 v[16:19], v4 offset:512
    ds_read_b128 v[116:119], v5 offset:0
    ds_read_b128 v[120:123], v5 offset:1024
    ds_read_b128 v[124:127], v5 offset:2048
    ds_read_b128 v[128:131], v5 offset:3072
    ds_read_b128 v[132:135], v5 offset:4096
    ds_read_b128 v[136:139], v5 offset:5120
    ds_read_b128 v[140:143], v5 offset:6144
    ds_read_b128 v[144:147], v5 offset:7168
    ds_read_b128 v[148:151], v5 offset:8192
    ds_read_b128 v[152:155], v5 offset:9216
    v_mul_u32_u24 v158, 80, v158
    v_lshl_add_u32 v4, v159, 4, v158
    s_and_b32 s87, s2, 7
    s_lshl_b32 s87, s87, 3
    s_add_u32 s87, s87, s22
    s_lshl1_add_u32 s87, s87, s79
    s_mul_i32 s87, s87, 20480
    s_bfe_u32 s38, s2, 0x20003
    s_mul_i32 s38, s38, 320
    s_add_u32 s87, s87, s38
    s_lshl_b32 s38, s80, 6
    s_add_u32 s87, s87, s38
    s_xor_b32 s38, s78, 1
    s_mul_i32 s38, s38, 6144
    s_add_u32 s38, s38, 73728
    v_add_u32 v6, s38, v0
    s_xor_b32 s38, s78, 2
    s_mul_i32 s38, s38, 6144
    s_add_u32 s38, s38, 75776
    v_add_u32 v7, s38, v0
    s_xor_b32 s38, s78, 3
    s_mul_i32 s38, s38, 6144
    s_add_u32 s38, s38, 77824
    v_add_u32 v8, s38, v0
    s_mul_i32 s38, s78, 6144
    s_add_u32 s38, s38, 73728
    v_add_u32 v9, s38, v0
    v_lshrrev_b32 v5, 1, v0
    v_add_u32 v156, s72, v0
    v_add_u32 v158, s72, v5
    v_add_u32 v157, s73, v0
    v_add_u32 v159, s73, v5
    v_pk_mov_b32 v[20:21], 0, 0
    v_pk_mov_b32 v[22:23], 0, 0
    v_pk_mov_b32 v[24:25], 0, 0
    v_pk_mov_b32 v[26:27], 0, 0
    v_pk_mov_b32 v[28:29], 0, 0
    v_pk_mov_b32 v[30:31], 0, 0
    v_pk_mov_b32 v[32:33], 0, 0
    v_pk_mov_b32 v[34:35], 0, 0
    v_pk_mov_b32 v[36:37], 0, 0
    v_pk_mov_b32 v[38:39], 0, 0
    v_pk_mov_b32 v[40:41], 0, 0
    v_pk_mov_b32 v[42:43], 0, 0
    s_waitcnt vmcnt(0) lgkmcnt(0)
    s_barrier
    s_barrier
    ds_read_b128 v[44:47], v156 offset:0
    ds_read_b128 v[48:51], v157 offset:0
    ds_read_b128 v[52:55], v156 offset:1024
    ds_read_b128 v[56:59], v157 offset:1024
    ds_read_b128 v[60:63], v156 offset:2048
    ds_read_b128 v[64:67], v157 offset:2048
    ds_read_b128 v[68:71], v156 offset:3072
    ds_read_b128 v[72:75], v157 offset:3072
    ds_read_b64 v[160:161], v158 offset:4096
    ds_read_b64 v[162:163], v158 offset:4608
    ds_read_b64 v[164:165], v159 offset:4096
    ds_read_b64 v[166:167], v159 offset:4608
    s_waitcnt lgkmcnt(11)
    v_max3_u32 v5, v44, v45, v46
    v_max_u32 v5, v5, v47
    v_cmp_eq_u32 vcc, -1, v5
    s_cbranch_vccnz k2A_n0
    v_mfma_f32_16x16x32_bf16 v[12:15], v[76:79], v[44:47], v[12:15]
    v_mfma_f32_16x16x32_bf16 v[16:19], v[80:83], v[44:47], v[16:19]
    v_mfma_f32_16x16x32_bf16 v[20:23], v[116:119], v[44:47], v[20:23]
    v_mfma_f32_16x16x32_bf16 v[24:27], v[120:123], v[44:47], v[24:27]
    s_bitset0_b32 s81, 0
k2A_n0:
    s_waitcnt lgkmcnt(10)
    v_max3_u32 v5, v48, v49, v50
    v_max_u32 v5, v5, v51
    v_cmp_eq_u32 vcc, -1, v5
    s_cbranch_vccnz k2A_n1
    v_mfma_f32_16x16x32_bf16 v[28:31], v[76:79], v[48:51], v[28:31]
    v_mfma_f32_16x16x32_bf16 v[32:35], v[80:83], v[48:51], v[32:35]
    v_mfma_f32_16x16x32_bf16 v[36:39], v[116:119], v[48:51], v[36:39]
    v_mfma_f32_16x16x32_bf16 v[40:43], v[120:123], v[48:51], v[40:43]
    s_bitset0_b32 s81, 1
k2A_n1:
    s_waitcnt lgkmcnt(9)
    v_max3_u32 v5, v52, v53, v54
    v_max_u32 v5, v5, v55
    v_cmp_eq_u32 vcc, -1, v5
    s_cbranch_vccnz k2A_n2
    v_mfma_f32_16x16x32_bf16 v[12:15], v[84:87], v[52:55], v[12:15]
    v_mfma_f32_16x16x32_bf16 v[16:19], v[88:91], v[52:55], v[16:19]
    v_mfma_f32_16x16x32_bf16 v[20:23], v[124:127], v[52:55], v[20:23]
    v_mfma_f32_16x16x32_bf16 v[24:27], v[128:131], v[52:55], v[24:27]
    s_bitset0_b32 s81, 2
k2A_n2:
    s_waitcnt lgkmcnt(8)
    v_max3_u32 v5, v56, v57, v58
    v_max_u32 v5, v5, v59
    v_cmp_eq_u32 vcc, -1, v5
    s_cbranch_vccnz k2A_n3
    v_mfma_f32_16x16x32_bf16 v[28:31], v[84:87], v[56:59], v[28:31]
    v_mfma_f32_16x16x32_bf16 v[32:35], v[88:91], v[56:59], v[32:35]
    v_mfma_f32_16x16x32_bf16 v[36:39], v[124:127], v[56:59], v[36:39]
    v_mfma_f32_16x16x32_bf16 v[40:43], v[128:131], v[56:59], v[40:43]
    s_bitset0_b32 s81, 3
k2A_n3:
    s_waitcnt lgkmcnt(7)
    v_max3_u32 v5, v60, v61, v62
    v_max_u32 v5, v5, v63
    v_cmp_eq_u32 vcc, -1, v5
    s_cbranch_vccnz k2A_n4
    v_mfma_f32_16x16x32_bf16 v[12:15], v[92:95], v[60:63], v[12:15]
    v_mfma_f32_16x16x32_bf16 v[16:19], v[96:99], v[60:63], v[16:19]
    v_mfma_f32_16x16x32_bf16 v[20:23], v[132:135], v[60:63], v[20:23]
    v_mfma_f32_16x16x32_bf16 v[24:27], v[136:139], v[60:63], v[24:27]
    s_bitset0_b32 s81, 4
k2A_n4:
    s_waitcnt lgkmcnt(6)
    v_max3_u32 v5, v64, v65, v66
    v_max_u32 v5, v5, v67
    v_cmp_eq_u32 vcc, -1, v5
    s_cbranch_vccnz k2A_n5
    v_mfma_f32_16x16x32_bf16 v[28:31], v[92:95], v[64:67], v[28:31]
    v_mfma_f32_16x16x32_bf16 v[32:35], v[96:99], v[64:67], v[32:35]
    v_mfma_f32_16x16x32_bf16 v[36:39], v[132:135], v[64:67], v[36:39]
    v_mfma_f32_16x16x32_bf16 v[40:43], v[136:139], v[64:67], v[40:43]
    s_bitset0_b32 s81, 5
k2A_n5:
    s_waitcnt lgkmcnt(5)
    v_max3_u32 v5, v68, v69, v70
    v_max_u32 v5, v5, v71
    v_cmp_eq_u32 vcc, -1, v5
    s_cbranch_vccnz k2A_n6
    v_mfma_f32_16x16x32_bf16 v[12:15], v[100:103], v[68:71], v[12:15]
    v_mfma_f32_16x16x32_bf16 v[16:19], v[104:107], v[68:71], v[16:19]
    v_mfma_f32_16x16x32_bf16 v[20:23], v[140:143], v[68:71], v[20:23]
    v_mfma_f32_16x16x32_bf16 v[24:27], v[144:147], v[68:71], v[24:27]
    s_bitset0_b32 s81, 6
k2A_n6:
    s_waitcnt lgkmcnt(4)
    v_max3_u32 v5, v72, v73, v74
    v_max_u32 v5, v5, v75
    v_cmp_eq_u32 vcc, -1, v5
    s_cbranch_vccnz k2A_n7
    v_mfma_f32_16x16x32_bf16 v[28:31], v[100:103], v[72:75], v[28:31]
    v_mfma_f32_16x16x32_bf16 v[32:35], v[104:107], v[72:75], v[32:35]
    v_mfma_f32_16x16x32_bf16 v[36:39], v[140:143], v[72:75], v[36:39]
    v_mfma_f32_16x16x32_bf16 v[40:43], v[144:147], v[72:75], v[40:43]
    s_bitset0_b32 s81, 7
k2A_n7:
    s_waitcnt lgkmcnt(2)
    v_max3_u32 v5, v160, v161, v162
    v_max_u32 v5, v5, v163
    v_cmp_eq_u32 vcc, -1, v5
    s_cbranch_vccnz k2A_n8
    v_mfma_f32_16x16x32_bf16 v[12:15], v[108:111], v[160:163], v[12:15]
    v_mfma_f32_16x16x32_bf16 v[16:19], v[112:115], v[160:163], v[16:19]
    v_mfma_f32_16x16x32_bf16 v[20:23], v[148:151], v[160:163], v[20:23]
    v_mfma_f32_16x16x32_bf16 v[24:27], v[152:155], v[160:163], v[24:27]
    s_bitset0_b32 s81, 8
k2A_n8:
    s_waitcnt lgkmcnt(0)
    v_max3_u32 v5, v164, v165, v166
    v_max_u32 v5, v5, v167
    v_cmp_eq_u32 vcc, -1, v5
    s_cbranch_vccnz k2A_n9
    v_mfma_f32_16x16x32_bf16 v[28:31], v[108:111], v[164:167], v[28:31]
    v_mfma_f32_16x16x32_bf16 v[32:35], v[112:115], v[164:167], v[32:35]
    v_mfma_f32_16x16x32_bf16 v[36:39], v[148:151], v[164:167], v[36:39]
    v_mfma_f32_16x16x32_bf16 v[40:43], v[152:155], v[164:167], v[40:43]
    s_bitset0_b32 s81, 9
k2A_n9:
    s_cmp_lg_u32 s81, 0
    s_cbranch_scc1 k2A_slow0
k2A_done:
    s_nop 5
    ds_write_b128 v6, v[20:23] offset:0
    ds_write_b128 v6, v[24:27] offset:1024
    ds_write_b128 v7, v[28:31] offset:0
    ds_write_b128 v7, v[32:35] offset:1024
    ds_write_b128 v8, v[36:39] offset:0
    ds_write_b128 v8, v[40:43] offset:1024
    s_waitcnt lgkmcnt(0)
    s_barrier
    ds_read_b128 v[44:47], v9 offset:0
    ds_read_b128 v[48:51], v9 offset:1024
    ds_read_b128 v[52:55], v9 offset:2048
    ds_read_b128 v[56:59], v9 offset:3072
    ds_read_b128 v[60:63], v9 offset:4096
    ds_read_b128 v[64:67], v9 offset:5120
    s_waitcnt lgkmcnt(4)
    v_pk_add_f32 v[12:13], v[12:13], v[44:45]
    v_pk_add_f32 v[14:15], v[14:15], v[46:47]
    v_pk_add_f32 v[16:17], v[16:17], v[48:49]
    v_pk_add_f32 v[18:19], v[18:19], v[50:51]
    s_waitcnt lgkmcnt(2)
    v_pk_add_f32 v[12:13], v[12:13], v[52:53]
    v_pk_add_f32 v[14:15], v[14:15], v[54:55]
    v_pk_add_f32 v[16:17], v[16:17], v[56:57]
    v_pk_add_f32 v[18:19], v[18:19], v[58:59]
    s_waitcnt lgkmcnt(0)
    v_pk_add_f32 v[12:13], v[12:13], v[60:61]
    v_pk_add_f32 v[14:15], v[14:15], v[62:63]
    v_pk_add_f32 v[16:17], v[16:17], v[64:65]
    v_pk_add_f32 v[18:19], v[18:19], v[66:67]
    v_cvt_pk_bf16_f32 v12, v12, v13
    v_cvt_pk_bf16_f32 v13, v14, v15
    v_cvt_pk_bf16_f32 v14, v16, v17
    v_cvt_pk_bf16_f32 v15, v18, v19
    buffer_store_dwordx4 v[12:15], v4, s[60:63], s87 offen sc0 sc1
    s_waitcnt vmcnt(0)
    s_endpgm
k2_pb:
    s_mul_i32 s38, s80, 30720
    s_lshl_b32 s39, s79, 8
    s_add_u32 s38, s38, s39
    s_add_u32 s38, s38, 75776
    v_add_u32 v4, s38, v158
    v_lshrrev_b32 v5, 1, v159
    v_mad_u32_u24 v4, v5, s85, v4
    v_and_b32 v5, 1, v159
    v_lshl_add_u32 v4, v5, 9, v4
    ds_read_b128 v[12:15], v4
    v_mul_u32_u24 v158, 80, v158
    v_lshl_add_u32 v4, v159, 3, v158
    s_and_b32 s87, s2, 7
    s_lshl_b32 s87, s87, 3
    s_add_u32 s87, s87, s22
    s_lshl1_add_u32 s87, s87, s79
    s_mul_i32 s87, s87, 20480
    s_bfe_u32 s38, s2, 0x20003
    s_mul_i32 s38, s38, 320
    s_add_u32 s87, s87, s38
    s_lshl_b32 s38, s80, 5
    s_add_u32 s87, s87, s38
    s_add_u32 s87, s87, 128
    s_xor_b32 s38, s78, 1
    s_mul_i32 s38, s38, 3072
    s_add_u32 s38, s38, 98304
    v_add_u32 v6, s38, v0
    s_xor_b32 s38, s78, 2
    s_mul_i32 s38, s38, 3072
    s_add_u32 s38, s38, 99328
    v_add_u32 v7, s38, v0
    s_xor_b32 s38, s78, 3
    s_mul_i32 s38, s38, 3072
    s_add_u32 s38, s38, 100352
    v_add_u32 v8, s38, v0
    s_mul_i32 s38, s78, 3072
    s_add_u32 s38, s38, 98304
    v_add_u32 v9, s38, v0
    v_lshrrev_b32 v5, 1, v0
    v_add_u32 v156, s72, v0
    v_add_u32 v158, s72, v5
    v_add_u32 v157, s73, v0
    v_add_u32 v159, s73, v5
    v_pk_mov_b32 v[16:17], 0, 0
    v_pk_mov_b32 v[18:19], 0, 0
    v_pk_mov_b32 v[20:21], 0, 0
    v_pk_mov_b32 v[22:23], 0, 0
    v_pk_mov_b32 v[24:25], 0, 0
    v_pk_mov_b32 v[26:27], 0, 0
    s_waitcnt vmcnt(0) lgkmcnt(0)
    s_barrier
    s_barrier
    ds_read_b128 v[44:47], v156 offset:0
    ds_read_b128 v[48:51], v157 offset:0
    ds_read_b128 v[52:55], v156 offset:1024
    ds_read_b128 v[56:59], v157 offset:1024
    ds_read_b128 v[60:63], v156 offset:2048
    ds_read_b128 v[64:67], v157 offset:2048
    ds_read_b128 v[68:71], v156 offset:3072
    ds_read_b128 v[72:75], v157 offset:3072
    ds_read_b64 v[160:161], v158 offset:4096
    ds_read_b64 v[162:163], v158 offset:4608
    ds_read_b64 v[164:165], v159 offset:4096
    ds_read_b64 v[166:167], v159 offset:4608
    s_waitcnt lgkmcnt(11)
    v_max3_u32 v5, v44, v45, v46
    v_max_u32 v5, v5, v47
    v_cmp_eq_u32 vcc, -1, v5
    s_cbranch_vccnz k2B_n0
    v_mfma_f32_16x16x32_bf16 v[12:15], v[76:79], v[44:47], v[12:15]
    v_mfma_f32_16x16x32_bf16 v[16:19], v[80:83], v[44:47], v[16:19]
    s_bitset0_b32 s81, 0
k2B_n0:
    s_waitcnt lgkmcnt(10)
    v_max3_u32 v5, v48, v49, v50
    v_max_u32 v5, v5, v51
    v_cmp_eq_u32 vcc, -1, v5
    s_cbranch_vccnz k2B_n1
    v_mfma_f32_16x16x32_bf16 v[20:23], v[76:79], v[48:51], v[20:23]
    v_mfma_f32_16x16x32_bf16 v[24:27], v[80:83], v[48:51], v[24:27]
    s_bitset0_b32 s81, 1
k2B_n1:
    s_waitcnt lgkmcnt(9)
    v_max3_u32 v5, v52, v53, v54
    v_max_u32 v5, v5, v55
    v_cmp_eq_u32 vcc, -1, v5
    s_cbranch_vccnz k2B_n2
    v_mfma_f32_16x16x32_bf16 v[12:15], v[84:87], v[52:55], v[12:15]
    v_mfma_f32_16x16x32_bf16 v[16:19], v[88:91], v[52:55], v[16:19]
    s_bitset0_b32 s81, 2
k2B_n2:
    s_waitcnt lgkmcnt(8)
    v_max3_u32 v5, v56, v57, v58
    v_max_u32 v5, v5, v59
    v_cmp_eq_u32 vcc, -1, v5
    s_cbranch_vccnz k2B_n3
    v_mfma_f32_16x16x32_bf16 v[20:23], v[84:87], v[56:59], v[20:23]
    v_mfma_f32_16x16x32_bf16 v[24:27], v[88:91], v[56:59], v[24:27]
    s_bitset0_b32 s81, 3
k2B_n3:
    s_waitcnt lgkmcnt(7)
    v_max3_u32 v5, v60, v61, v62
    v_max_u32 v5, v5, v63
    v_cmp_eq_u32 vcc, -1, v5
    s_cbranch_vccnz k2B_n4
    v_mfma_f32_16x16x32_bf16 v[12:15], v[92:95], v[60:63], v[12:15]
    v_mfma_f32_16x16x32_bf16 v[16:19], v[96:99], v[60:63], v[16:19]
    s_bitset0_b32 s81, 4
k2B_n4:
    s_waitcnt lgkmcnt(6)
    v_max3_u32 v5, v64, v65, v66
    v_max_u32 v5, v5, v67
    v_cmp_eq_u32 vcc, -1, v5
    s_cbranch_vccnz k2B_n5
    v_mfma_f32_16x16x32_bf16 v[20:23], v[92:95], v[64:67], v[20:23]
    v_mfma_f32_16x16x32_bf16 v[24:27], v[96:99], v[64:67], v[24:27]
    s_bitset0_b32 s81, 5
k2B_n5:
    s_waitcnt lgkmcnt(5)
    v_max3_u32 v5, v68, v69, v70
    v_max_u32 v5, v5, v71
    v_cmp_eq_u32 vcc, -1, v5
    s_cbranch_vccnz k2B_n6
    v_mfma_f32_16x16x32_bf16 v[12:15], v[100:103], v[68:71], v[12:15]
    v_mfma_f32_16x16x32_bf16 v[16:19], v[104:107], v[68:71], v[16:19]
    s_bitset0_b32 s81, 6
k2B_n6:
    s_waitcnt lgkmcnt(4)
    v_max3_u32 v5, v72, v73, v74
    v_max_u32 v5, v5, v75
    v_cmp_eq_u32 vcc, -1, v5
    s_cbranch_vccnz k2B_n7
    v_mfma_f32_16x16x32_bf16 v[20:23], v[100:103], v[72:75], v[20:23]
    v_mfma_f32_16x16x32_bf16 v[24:27], v[104:107], v[72:75], v[24:27]
    s_bitset0_b32 s81, 7
k2B_n7:
    s_waitcnt lgkmcnt(2)
    v_max3_u32 v5, v160, v161, v162
    v_max_u32 v5, v5, v163
    v_cmp_eq_u32 vcc, -1, v5
    s_cbranch_vccnz k2B_n8
    v_mfma_f32_16x16x32_bf16 v[12:15], v[108:111], v[160:163], v[12:15]
    v_mfma_f32_16x16x32_bf16 v[16:19], v[112:115], v[160:163], v[16:19]
    s_bitset0_b32 s81, 8
k2B_n8:
    s_waitcnt lgkmcnt(0)
    v_max3_u32 v5, v164, v165, v166
    v_max_u32 v5, v5, v167
    v_cmp_eq_u32 vcc, -1, v5
    s_cbranch_vccnz k2B_n9
    v_mfma_f32_16x16x32_bf16 v[20:23], v[108:111], v[164:167], v[20:23]
    v_mfma_f32_16x16x32_bf16 v[24:27], v[112:115], v[164:167], v[24:27]
    s_bitset0_b32 s81, 9
k2B_n9:
    s_cmp_lg_u32 s81, 0
    s_cbranch_scc1 k2B_slow0
k2B_done:
    s_nop 5
    ds_write_b128 v6, v[16:19] offset:0
    ds_write_b128 v7, v[20:23] offset:0
    ds_write_b128 v8, v[24:27] offset:0
    s_waitcnt lgkmcnt(0)
    s_barrier
    ds_read_b128 v[44:47], v9 offset:0
    ds_read_b128 v[48:51], v9 offset:1024
    ds_read_b128 v[52:55], v9 offset:2048
    s_waitcnt lgkmcnt(2)
    v_pk_add_f32 v[12:13], v[12:13], v[44:45]
    v_pk_add_f32 v[14:15], v[14:15], v[46:47]
    s_waitcnt lgkmcnt(1)
    v_pk_add_f32 v[12:13], v[12:13], v[48:49]
    v_pk_add_f32 v[14:15], v[14:15], v[50:51]
    s_waitcnt lgkmcnt(0)
    v_pk_add_f32 v[12:13], v[12:13], v[52:53]
    v_pk_add_f32 v[14:15], v[14:15], v[54:55]
    v_cvt_pk_bf16_f32 v12, v12, v13
    v_cvt_pk_bf16_f32 v13, v14, v15
    buffer_store_dwordx2 v[12:13], v4, s[60:63], s87 offen sc0 sc1
    s_waitcnt vmcnt(0)
    s_endpgm
k2A_slow0:
    s_and_b32 s38, s81, 15
    s_cbranch_scc0 k2A_g00
    s_bitcmp1_b32 s81, 0
    s_cbranch_scc0 k2A_s00
    ds_read_b128 v[44:47], v156 offset:0
    s_waitcnt lgkmcnt(0)
    v_max3_u32 v5, v44, v45, v46
    v_max_u32 v5, v5, v47
    v_cmp_eq_u32 vcc, -1, v5
    s_cbranch_vccnz k2A_s00
    v_mfma_f32_16x16x32_bf16 v[12:15], v[76:79], v[44:47], v[12:15]
    v_mfma_f32_16x16x32_bf16 v[16:19], v[80:83], v[44:47], v[16:19]
    v_mfma_f32_16x16x32_bf16 v[20:23], v[116:119], v[44:47], v[20:23]
    v_mfma_f32_16x16x32_bf16 v[24:27], v[120:123], v[44:47], v[24:27]
    s_bitset0_b32 s81, 0
k2A_s00:
    s_bitcmp1_b32 s81, 1
    s_cbranch_scc0 k2A_s01
    ds_read_b128 v[48:51], v157 offset:0
    s_waitcnt lgkmcnt(0)
    v_max3_u32 v5, v48, v49, v50
    v_max_u32 v5, v5, v51
    v_cmp_eq_u32 vcc, -1, v5
    s_cbranch_vccnz k2A_s01
    v_mfma_f32_16x16x32_bf16 v[28:31], v[76:79], v[48:51], v[28:31]
    v_mfma_f32_16x16x32_bf16 v[32:35], v[80:83], v[48:51], v[32:35]
    v_mfma_f32_16x16x32_bf16 v[36:39], v[116:119], v[48:51], v[36:39]
    v_mfma_f32_16x16x32_bf16 v[40:43], v[120:123], v[48:51], v[40:43]
    s_bitset0_b32 s81, 1
k2A_s01:
    s_bitcmp1_b32 s81, 2
    s_cbranch_scc0 k2A_s02
    ds_read_b128 v[52:55], v156 offset:1024
    s_waitcnt lgkmcnt(0)
    v_max3_u32 v5, v52, v53, v54
    v_max_u32 v5, v5, v55
    v_cmp_eq_u32 vcc, -1, v5
    s_cbranch_vccnz k2A_s02
    v_mfma_f32_16x16x32_bf16 v[12:15], v[84:87], v[52:55], v[12:15]
    v_mfma_f32_16x16x32_bf16 v[16:19], v[88:91], v[52:55], v[16:19]
    v_mfma_f32_16x16x32_bf16 v[20:23], v[124:127], v[52:55], v[20:23]
    v_mfma_f32_16x16x32_bf16 v[24:27], v[128:131], v[52:55], v[24:27]
    s_bitset0_b32 s81, 2
k2A_s02:
    s_bitcmp1_b32 s81, 3
    s_cbranch_scc0 k2A_s03
    ds_read_b128 v[56:59], v157 offset:1024
    s_waitcnt lgkmcnt(0)
    v_max3_u32 v5, v56, v57, v58
    v_max_u32 v5, v5, v59
    v_cmp_eq_u32 vcc, -1, v5
    s_cbranch_vccnz k2A_s03
    v_mfma_f32_16x16x32_bf16 v[28:31], v[84:87], v[56:59], v[28:31]
    v_mfma_f32_16x16x32_bf16 v[32:35], v[88:91], v[56:59], v[32:35]
    v_mfma_f32_16x16x32_bf16 v[36:39], v[124:127], v[56:59], v[36:39]
    v_mfma_f32_16x16x32_bf16 v[40:43], v[128:131], v[56:59], v[40:43]
    s_bitset0_b32 s81, 3
k2A_s03:
k2A_g00:
    s_and_b32 s38, s81, 240
    s_cbranch_scc0 k2A_g04
    s_bitcmp1_b32 s81, 4
    s_cbranch_scc0 k2A_s04
    ds_read_b128 v[60:63], v156 offset:2048
    s_waitcnt lgkmcnt(0)
    v_max3_u32 v5, v60, v61, v62
    v_max_u32 v5, v5, v63
    v_cmp_eq_u32 vcc, -1, v5
    s_cbranch_vccnz k2A_s04
    v_mfma_f32_16x16x32_bf16 v[12:15], v[92:95], v[60:63], v[12:15]
    v_mfma_f32_16x16x32_bf16 v[16:19], v[96:99], v[60:63], v[16:19]
    v_mfma_f32_16x16x32_bf16 v[20:23], v[132:135], v[60:63], v[20:23]
    v_mfma_f32_16x16x32_bf16 v[24:27], v[136:139], v[60:63], v[24:27]
    s_bitset0_b32 s81, 4
k2A_s04:
    s_bitcmp1_b32 s81, 5
    s_cbranch_scc0 k2A_s05
    ds_read_b128 v[64:67], v157 offset:2048
    s_waitcnt lgkmcnt(0)
    v_max3_u32 v5, v64, v65, v66
    v_max_u32 v5, v5, v67
    v_cmp_eq_u32 vcc, -1, v5
    s_cbranch_vccnz k2A_s05
    v_mfma_f32_16x16x32_bf16 v[28:31], v[92:95], v[64:67], v[28:31]
    v_mfma_f32_16x16x32_bf16 v[32:35], v[96:99], v[64:67], v[32:35]
    v_mfma_f32_16x16x32_bf16 v[36:39], v[132:135], v[64:67], v[36:39]
    v_mfma_f32_16x16x32_bf16 v[40:43], v[136:139], v[64:67], v[40:43]
    s_bitset0_b32 s81, 5
k2A_s05:
    s_bitcmp1_b32 s81, 6
    s_cbranch_scc0 k2A_s06
    ds_read_b128 v[68:71], v156 offset:3072
    s_waitcnt lgkmcnt(0)
    v_max3_u32 v5, v68, v69, v70
    v_max_u32 v5, v5, v71
    v_cmp_eq_u32 vcc, -1, v5
    s_cbranch_vccnz k2A_s06
    v_mfma_f32_16x16x32_bf16 v[12:15], v[100:103], v[68:71], v[12:15]
    v_mfma_f32_16x16x32_bf16 v[16:19], v[104:107], v[68:71], v[16:19]
    v_mfma_f32_16x16x32_bf16 v[20:23], v[140:143], v[68:71], v[20:23]
    v_mfma_f32_16x16x32_bf16 v[24:27], v[144:147], v[68:71], v[24:27]
    s_bitset0_b32 s81, 6
k2A_s06:
    s_bitcmp1_b32 s81, 7
    s_cbranch_scc0 k2A_s07
    ds_read_b128 v[72:75], v157 offset:3072
    s_waitcnt lgkmcnt(0)
    v_max3_u32 v5, v72, v73, v74
    v_max_u32 v5, v5, v75
    v_cmp_eq_u32 vcc, -1, v5
    s_cbranch_vccnz k2A_s07
    v_mfma_f32_16x16x32_bf16 v[28:31], v[100:103], v[72:75], v[28:31]
    v_mfma_f32_16x16x32_bf16 v[32:35], v[104:107], v[72:75], v[32:35]
    v_mfma_f32_16x16x32_bf16 v[36:39], v[140:143], v[72:75], v[36:39]
    v_mfma_f32_16x16x32_bf16 v[40:43], v[144:147], v[72:75], v[40:43]
    s_bitset0_b32 s81, 7
k2A_s07:
k2A_g04:
    s_and_b32 s38, s81, 768
    s_cbranch_scc0 k2A_g08
    s_bitcmp1_b32 s81, 8
    s_cbranch_scc0 k2A_s08
    ds_read_b64 v[160:161], v158 offset:4096
    ds_read_b64 v[162:163], v158 offset:4608
    s_waitcnt lgkmcnt(0)
    v_max3_u32 v5, v160, v161, v162
    v_max_u32 v5, v5, v163
    v_cmp_eq_u32 vcc, -1, v5
    s_cbranch_vccnz k2A_s08
    v_mfma_f32_16x16x32_bf16 v[12:15], v[108:111], v[160:163], v[12:15]
    v_mfma_f32_16x16x32_bf16 v[16:19], v[112:115], v[160:163], v[16:19]
    v_mfma_f32_16x16x32_bf16 v[20:23], v[148:151], v[160:163], v[20:23]
    v_mfma_f32_16x16x32_bf16 v[24:27], v[152:155], v[160:163], v[24:27]
    s_bitset0_b32 s81, 8
k2A_s08:
    s_bitcmp1_b32 s81, 9
    s_cbranch_scc0 k2A_s09
    ds_read_b64 v[164:165], v159 offset:4096
    ds_read_b64 v[166:167], v159 offset:4608
    s_waitcnt lgkmcnt(0)
    v_max3_u32 v5, v164, v165, v166
    v_max_u32 v5, v5, v167
    v_cmp_eq_u32 vcc, -1, v5
    s_cbranch_vccnz k2A_s09
    v_mfma_f32_16x16x32_bf16 v[28:31], v[108:111], v[164:167], v[28:31]
    v_mfma_f32_16x16x32_bf16 v[32:35], v[112:115], v[164:167], v[32:35]
    v_mfma_f32_16x16x32_bf16 v[36:39], v[148:151], v[164:167], v[36:39]
    v_mfma_f32_16x16x32_bf16 v[40:43], v[152:155], v[164:167], v[40:43]
    s_bitset0_b32 s81, 9
k2A_s09:
k2A_g08:
    s_cmp_eq_u32 s81, 0
    s_cbranch_scc1 k2A_done
    s_sub_u32 s82, s82, 1
    s_cbranch_scc0 k2A_slow0
k2A_own:
    s_and_b32 s38, s2, 7
    s_lshl_b32 s38, s38, 3
    s_add_u32 s38, s38, s22
    s_lshl1_add_u32 s38, s38, s79
    s_mul_i32 s41, s38, 20480
    s_xor_b32 s38, s38, 1
    s_mul_i32 s42, s38, 20480
    s_lshl_b32 s38, s78, 10
    s_add_u32 s38, s38, 16384
    s_add_u32 s43, s41, s38
    s_add_u32 s44, s42, s38
    s_lshl_b32 s38, s78, 12
    s_add_u32 s41, s41, s38
    s_add_u32 s42, s42, s38
    s_mov_b32 s82, 400000
k2A_slow1:
    s_and_b32 s38, s81, 15
    s_cbranch_scc0 k2A_g10
    s_bitcmp1_b32 s81, 0
    s_cbranch_scc0 k2A_s10
    ds_read_b128 v[44:47], v156 offset:0
    s_mov_b32 m0, s72
    s_nop 0
    buffer_load_dwordx4 v0, s[16:19], s41 offen offset:0 sc1 lds
    s_waitcnt lgkmcnt(0)
    v_max3_u32 v5, v44, v45, v46
    v_max_u32 v5, v5, v47
    v_cmp_eq_u32 vcc, -1, v5
    s_cbranch_vccnz k2A_s10
    v_mfma_f32_16x16x32_bf16 v[12:15], v[76:79], v[44:47], v[12:15]
    v_mfma_f32_16x16x32_bf16 v[16:19], v[80:83], v[44:47], v[16:19]
    v_mfma_f32_16x16x32_bf16 v[20:23], v[116:119], v[44:47], v[20:23]
    v_mfma_f32_16x16x32_bf16 v[24:27], v[120:123], v[44:47], v[24:27]
    s_bitset0_b32 s81, 0
k2A_s10:
    s_bitcmp1_b32 s81, 1
    s_cbranch_scc0 k2A_s11
    ds_read_b128 v[48:51], v157 offset:0
    s_mov_b32 m0, s73
    s_nop 0
    buffer_load_dwordx4 v0, s[16:19], s42 offen offset:0 sc1 lds
    s_waitcnt lgkmcnt(0)
    v_max3_u32 v5, v48, v49, v50
    v_max_u32 v5, v5, v51
    v_cmp_eq_u32 vcc, -1, v5
    s_cbranch_vccnz k2A_s11
    v_mfma_f32_16x16x32_bf16 v[28:31], v[76:79], v[48:51], v[28:31]
    v_mfma_f32_16x16x32_bf16 v[32:35], v[80:83], v[48:51], v[32:35]
    v_mfma_f32_16x16x32_bf16 v[36:39], v[116:119], v[48:51], v[36:39]
    v_mfma_f32_16x16x32_bf16 v[40:43], v[120:123], v[48:51], v[40:43]
    s_bitset0_b32 s81, 1
k2A_s11:
    s_bitcmp1_b32 s81, 2
    s_cbranch_scc0 k2A_s12
    ds_read_b128 v[52:55], v156 offset:1024
    s_mov_b32 m0, s72
    s_nop 0
    buffer_load_dwordx4 v0, s[16:19], s41 offen offset:1024 sc1 lds
    s_waitcnt lgkmcnt(0)
    v_max3_u32 v5, v52, v53, v54
    v_max_u32 v5, v5, v55
    v_cmp_eq_u32 vcc, -1, v5
    s_cbranch_vccnz k2A_s12
    v_mfma_f32_16x16x32_bf16 v[12:15], v[84:87], v[52:55], v[12:15]
    v_mfma_f32_16x16x32_bf16 v[16:19], v[88:91], v[52:55], v[16:19]
    v_mfma_f32_16x16x32_bf16 v[20:23], v[124:127], v[52:55], v[20:23]
    v_mfma_f32_16x16x32_bf16 v[24:27], v[128:131], v[52:55], v[24:27]
    s_bitset0_b32 s81, 2
k2A_s12:
    s_bitcmp1_b32 s81, 3
    s_cbranch_scc0 k2A_s13
    ds_read_b128 v[56:59], v157 offset:1024
    s_mov_b32 m0, s73
    s_nop 0
    buffer_load_dwordx4 v0, s[16:19], s42 offen offset:1024 sc1 lds
    s_waitcnt lgkmcnt(0)
    v_max3_u32 v5, v56, v57, v58
    v_max_u32 v5, v5, v59
    v_cmp_eq_u32 vcc, -1, v5
    s_cbranch_vccnz k2A_s13
    v_mfma_f32_16x16x32_bf16 v[28:31], v[84:87], v[56:59], v[28:31]
    v_mfma_f32_16x16x32_bf16 v[32:35], v[88:91], v[56:59], v[32:35]
    v_mfma_f32_16x16x32_bf16 v[36:39], v[124:127], v[56:59], v[36:39]
    v_mfma_f32_16x16x32_bf16 v[40:43], v[128:131], v[56:59], v[40:43]
    s_bitset0_b32 s81, 3
k2A_s13:
k2A_g10:
    s_and_b32 s38, s81, 240
    s_cbranch_scc0 k2A_g14
    s_bitcmp1_b32 s81, 4
    s_cbranch_scc0 k2A_s14
    ds_read_b128 v[60:63], v156 offset:2048
    s_mov_b32 m0, s72
    s_nop 0
    buffer_load_dwordx4 v0, s[16:19], s41 offen offset:2048 sc1 lds
    s_waitcnt lgkmcnt(0)
    v_max3_u32 v5, v60, v61, v62
    v_max_u32 v5, v5, v63
    v_cmp_eq_u32 vcc, -1, v5
    s_cbranch_vccnz k2A_s14
    v_mfma_f32_16x16x32_bf16 v[12:15], v[92:95], v[60:63], v[12:15]
    v_mfma_f32_16x16x32_bf16 v[16:19], v[96:99], v[60:63], v[16:19]
    v_mfma_f32_16x16x32_bf16 v[20:23], v[132:135], v[60:63], v[20:23]
    v_mfma_f32_16x16x32_bf16 v[24:27], v[136:139], v[60:63], v[24:27]
    s_bitset0_b32 s81, 4
k2A_s14:
    s_bitcmp1_b32 s81, 5
    s_cbranch_scc0 k2A_s15
    ds_read_b128 v[64:67], v157 offset:2048
    s_mov_b32 m0, s73
    s_nop 0
    buffer_load_dwordx4 v0, s[16:19], s42 offen offset:2048 sc1 lds
    s_waitcnt lgkmcnt(0)
    v_max3_u32 v5, v64, v65, v66
    v_max_u32 v5, v5, v67
    v_cmp_eq_u32 vcc, -1, v5
    s_cbranch_vccnz k2A_s15
    v_mfma_f32_16x16x32_bf16 v[28:31], v[92:95], v[64:67], v[28:31]
    v_mfma_f32_16x16x32_bf16 v[32:35], v[96:99], v[64:67], v[32:35]
    v_mfma_f32_16x16x32_bf16 v[36:39], v[132:135], v[64:67], v[36:39]
    v_mfma_f32_16x16x32_bf16 v[40:43], v[136:139], v[64:67], v[40:43]
    s_bitset0_b32 s81, 5
k2A_s15:
    s_bitcmp1_b32 s81, 6
    s_cbranch_scc0 k2A_s16
    ds_read_b128 v[68:71], v156 offset:3072
    s_mov_b32 m0, s72
    s_nop 0
    buffer_load_dwordx4 v0, s[16:19], s41 offen offset:3072 sc1 lds
    s_waitcnt lgkmcnt(0)
    v_max3_u32 v5, v68, v69, v70
    v_max_u32 v5, v5, v71
    v_cmp_eq_u32 vcc, -1, v5
    s_cbranch_vccnz k2A_s16
    v_mfma_f32_16x16x32_bf16 v[12:15], v[100:103], v[68:71], v[12:15]
    v_mfma_f32_16x16x32_bf16 v[16:19], v[104:107], v[68:71], v[16:19]
    v_mfma_f32_16x16x32_bf16 v[20:23], v[140:143], v[68:71], v[20:23]
    v_mfma_f32_16x16x32_bf16 v[24:27], v[144:147], v[68:71], v[24:27]
    s_bitset0_b32 s81, 6
k2A_s16:
    s_bitcmp1_b32 s81, 7
    s_cbranch_scc0 k2A_s17
    ds_read_b128 v[72:75], v157 offset:3072
    s_mov_b32 m0, s73
    s_nop 0
    buffer_load_dwordx4 v0, s[16:19], s42 offen offset:3072 sc1 lds
    s_waitcnt lgkmcnt(0)
    v_max3_u32 v5, v72, v73, v74
    v_max_u32 v5, v5, v75
    v_cmp_eq_u32 vcc, -1, v5
    s_cbranch_vccnz k2A_s17
    v_mfma_f32_16x16x32_bf16 v[28:31], v[100:103], v[72:75], v[28:31]
    v_mfma_f32_16x16x32_bf16 v[32:35], v[104:107], v[72:75], v[32:35]
    v_mfma_f32_16x16x32_bf16 v[36:39], v[140:143], v[72:75], v[36:39]
    v_mfma_f32_16x16x32_bf16 v[40:43], v[144:147], v[72:75], v[40:43]
    s_bitset0_b32 s81, 7
k2A_s17:
k2A_g14:
    s_and_b32 s38, s81, 768
    s_cbranch_scc0 k2A_g18
    s_bitcmp1_b32 s81, 8
    s_cbranch_scc0 k2A_s18
    ds_read_b64 v[160:161], v158 offset:4096
    ds_read_b64 v[162:163], v158 offset:4608
    s_add_u32 m0, s72, 4096
    s_nop 0
    buffer_load_dwordx4 v0, s[16:19], s43 offen offset:0 sc1 lds
    s_waitcnt lgkmcnt(0)
    v_max3_u32 v5, v160, v161, v162
    v_max_u32 v5, v5, v163
    v_cmp_eq_u32 vcc, -1, v5
    s_cbranch_vccnz k2A_s18
    v_mfma_f32_16x16x32_bf16 v[12:15], v[108:111], v[160:163], v[12:15]
    v_mfma_f32_16x16x32_bf16 v[16:19], v[112:115], v[160:163], v[16:19]
    v_mfma_f32_16x16x32_bf16 v[20:23], v[148:151], v[160:163], v[20:23]
    v_mfma_f32_16x16x32_bf16 v[24:27], v[152:155], v[160:163], v[24:27]
    s_bitset0_b32 s81, 8
k2A_s18:
    s_bitcmp1_b32 s81, 9
    s_cbranch_scc0 k2A_s19
    ds_read_b64 v[164:165], v159 offset:4096
    ds_read_b64 v[166:167], v159 offset:4608
    s_add_u32 m0, s73, 4096
    s_nop 0
    buffer_load_dwordx4 v0, s[16:19], s44 offen offset:0 sc1 lds
    s_waitcnt lgkmcnt(0)
    v_max3_u32 v5, v164, v165, v166
    v_max_u32 v5, v5, v167
    v_cmp_eq_u32 vcc, -1, v5
    s_cbranch_vccnz k2A_s19
    v_mfma_f32_16x16x32_bf16 v[28:31], v[108:111], v[164:167], v[28:31]
    v_mfma_f32_16x16x32_bf16 v[32:35], v[112:115], v[164:167], v[32:35]
    v_mfma_f32_16x16x32_bf16 v[36:39], v[148:151], v[164:167], v[36:39]
    v_mfma_f32_16x16x32_bf16 v[40:43], v[152:155], v[164:167], v[40:43]
    s_bitset0_b32 s81, 9
k2A_s19:
k2A_g18:
    s_cmp_eq_u32 s81, 0
    s_cbranch_scc1 k2A_done
    s_sub_u32 s82, s82, 1
    s_cbranch_scc0 k2A_slow1
    s_branch k2A_done
k2B_slow0:
    s_and_b32 s38, s81, 15
    s_cbranch_scc0 k2B_g00
    s_bitcmp1_b32 s81, 0
    s_cbranch_scc0 k2B_s00
    ds_read_b128 v[44:47], v156 offset:0
    s_waitcnt lgkmcnt(0)
    v_max3_u32 v5, v44, v45, v46
    v_max_u32 v5, v5, v47
    v_cmp_eq_u32 vcc, -1, v5
    s_cbranch_vccnz k2B_s00
    v_mfma_f32_16x16x32_bf16 v[12:15], v[76:79], v[44:47], v[12:15]
    v_mfma_f32_16x16x32_bf16 v[16:19], v[80:83], v[44:47], v[16:19]
    s_bitset0_b32 s81, 0
k2B_s00:
    s_bitcmp1_b32 s81, 1
    s_cbranch_scc0 k2B_s01
    ds_read_b128 v[48:51], v157 offset:0
    s_waitcnt lgkmcnt(0)
    v_max3_u32 v5, v48, v49, v50
    v_max_u32 v5, v5, v51
    v_cmp_eq_u32 vcc, -1, v5
    s_cbranch_vccnz k2B_s01
    v_mfma_f32_16x16x32_bf16 v[20:23], v[76:79], v[48:51], v[20:23]
    v_mfma_f32_16x16x32_bf16 v[24:27], v[80:83], v[48:51], v[24:27]
    s_bitset0_b32 s81, 1
k2B_s01:
    s_bitcmp1_b32 s81, 2
    s_cbranch_scc0 k2B_s02
    ds_read_b128 v[52:55], v156 offset:1024
    s_waitcnt lgkmcnt(0)
    v_max3_u32 v5, v52, v53, v54
    v_max_u32 v5, v5, v55
    v_cmp_eq_u32 vcc, -1, v5
    s_cbranch_vccnz k2B_s02
    v_mfma_f32_16x16x32_bf16 v[12:15], v[84:87], v[52:55], v[12:15]
    v_mfma_f32_16x16x32_bf16 v[16:19], v[88:91], v[52:55], v[16:19]
    s_bitset0_b32 s81, 2
k2B_s02:
    s_bitcmp1_b32 s81, 3
    s_cbranch_scc0 k2B_s03
    ds_read_b128 v[56:59], v157 offset:1024
    s_waitcnt lgkmcnt(0)
    v_max3_u32 v5, v56, v57, v58
    v_max_u32 v5, v5, v59
    v_cmp_eq_u32 vcc, -1, v5
    s_cbranch_vccnz k2B_s03
    v_mfma_f32_16x16x32_bf16 v[20:23], v[84:87], v[56:59], v[20:23]
    v_mfma_f32_16x16x32_bf16 v[24:27], v[88:91], v[56:59], v[24:27]
    s_bitset0_b32 s81, 3
k2B_s03:
k2B_g00:
    s_and_b32 s38, s81, 240
    s_cbranch_scc0 k2B_g04
    s_bitcmp1_b32 s81, 4
    s_cbranch_scc0 k2B_s04
    ds_read_b128 v[60:63], v156 offset:2048
    s_waitcnt lgkmcnt(0)
    v_max3_u32 v5, v60, v61, v62
    v_max_u32 v5, v5, v63
    v_cmp_eq_u32 vcc, -1, v5
    s_cbranch_vccnz k2B_s04
    v_mfma_f32_16x16x32_bf16 v[12:15], v[92:95], v[60:63], v[12:15]
    v_mfma_f32_16x16x32_bf16 v[16:19], v[96:99], v[60:63], v[16:19]
    s_bitset0_b32 s81, 4
k2B_s04:
    s_bitcmp1_b32 s81, 5
    s_cbranch_scc0 k2B_s05
    ds_read_b128 v[64:67], v157 offset:2048
    s_waitcnt lgkmcnt(0)
    v_max3_u32 v5, v64, v65, v66
    v_max_u32 v5, v5, v67
    v_cmp_eq_u32 vcc, -1, v5
    s_cbranch_vccnz k2B_s05
    v_mfma_f32_16x16x32_bf16 v[20:23], v[92:95], v[64:67], v[20:23]
    v_mfma_f32_16x16x32_bf16 v[24:27], v[96:99], v[64:67], v[24:27]
    s_bitset0_b32 s81, 5
k2B_s05:
    s_bitcmp1_b32 s81, 6
    s_cbranch_scc0 k2B_s06
    ds_read_b128 v[68:71], v156 offset:3072
    s_waitcnt lgkmcnt(0)
    v_max3_u32 v5, v68, v69, v70
    v_max_u32 v5, v5, v71
    v_cmp_eq_u32 vcc, -1, v5
    s_cbranch_vccnz k2B_s06
    v_mfma_f32_16x16x32_bf16 v[12:15], v[100:103], v[68:71], v[12:15]
    v_mfma_f32_16x16x32_bf16 v[16:19], v[104:107], v[68:71], v[16:19]
    s_bitset0_b32 s81, 6
k2B_s06:
    s_bitcmp1_b32 s81, 7
    s_cbranch_scc0 k2B_s07
    ds_read_b128 v[72:75], v157 offset:3072
    s_waitcnt lgkmcnt(0)
    v_max3_u32 v5, v72, v73, v74
    v_max_u32 v5, v5, v75
    v_cmp_eq_u32 vcc, -1, v5
    s_cbranch_vccnz k2B_s07
    v_mfma_f32_16x16x32_bf16 v[20:23], v[100:103], v[72:75], v[20:23]
    v_mfma_f32_16x16x32_bf16 v[24:27], v[104:107], v[72:75], v[24:27]
    s_bitset0_b32 s81, 7
k2B_s07:
k2B_g04:
    s_and_b32 s38, s81, 768
    s_cbranch_scc0 k2B_g08
    s_bitcmp1_b32 s81, 8
    s_cbranch_scc0 k2B_s08
    ds_read_b64 v[160:161], v158 offset:4096
    ds_read_b64 v[162:163], v158 offset:4608
    s_waitcnt lgkmcnt(0)
    v_max3_u32 v5, v160, v161, v162
    v_max_u32 v5, v5, v163
    v_cmp_eq_u32 vcc, -1, v5
    s_cbranch_vccnz k2B_s08
    v_mfma_f32_16x16x32_bf16 v[12:15], v[108:111], v[160:163], v[12:15]
    v_mfma_f32_16x16x32_bf16 v[16:19], v[112:115], v[160:163], v[16:19]
    s_bitset0_b32 s81, 8
k2B_s08:
    s_bitcmp1_b32 s81, 9
    s_cbranch_scc0 k2B_s09
    ds_read_b64 v[164:165], v159 offset:4096
    ds_read_b64 v[166:167], v159 offset:4608
    s_waitcnt lgkmcnt(0)
    v_max3_u32 v5, v164, v165, v166
    v_max_u32 v5, v5, v167
    v_cmp_eq_u32 vcc, -1, v5
    s_cbranch_vccnz k2B_s09
    v_mfma_f32_16x16x32_bf16 v[20:23], v[108:111], v[164:167], v[20:23]
    v_mfma_f32_16x16x32_bf16 v[24:27], v[112:115], v[164:167], v[24:27]
    s_bitset0_b32 s81, 9
k2B_s09:
k2B_g08:
    s_cmp_eq_u32 s81, 0
    s_cbranch_scc1 k2B_done
    s_sub_u32 s82, s82, 1
    s_cbranch_scc0 k2B_slow0
k2B_own:
    s_and_b32 s38, s2, 7
    s_lshl_b32 s38, s38, 3
    s_add_u32 s38, s38, s22
    s_lshl1_add_u32 s38, s38, s79
    s_mul_i32 s41, s38, 20480
    s_xor_b32 s38, s38, 1
    s_mul_i32 s42, s38, 20480
    s_lshl_b32 s38, s78, 10
    s_add_u32 s38, s38, 16384
    s_add_u32 s43, s41, s38
    s_add_u32 s44, s42, s38
    s_lshl_b32 s38, s78, 12
    s_add_u32 s41, s41, s38
    s_add_u32 s42, s42, s38
    s_mov_b32 s82, 400000
k2B_slow1:
    s_and_b32 s38, s81, 15
    s_cbranch_scc0 k2B_g10
    s_bitcmp1_b32 s81, 0
    s_cbranch_scc0 k2B_s10
    ds_read_b128 v[44:47], v156 offset:0
    s_mov_b32 m0, s72
    s_nop 0
    buffer_load_dwordx4 v0, s[16:19], s41 offen offset:0 sc1 lds
    s_waitcnt lgkmcnt(0)
    v_max3_u32 v5, v44, v45, v46
    v_max_u32 v5, v5, v47
    v_cmp_eq_u32 vcc, -1, v5
    s_cbranch_vccnz k2B_s10
    v_mfma_f32_16x16x32_bf16 v[12:15], v[76:79], v[44:47], v[12:15]
    v_mfma_f32_16x16x32_bf16 v[16:19], v[80:83], v[44:47], v[16:19]
    s_bitset0_b32 s81, 0
k2B_s10:
    s_bitcmp1_b32 s81, 1
    s_cbranch_scc0 k2B_s11
    ds_read_b128 v[48:51], v157 offset:0
    s_mov_b32 m0, s73
    s_nop 0
    buffer_load_dwordx4 v0, s[16:19], s42 offen offset:0 sc1 lds
    s_waitcnt lgkmcnt(0)
    v_max3_u32 v5, v48, v49, v50
    v_max_u32 v5, v5, v51
    v_cmp_eq_u32 vcc, -1, v5
    s_cbranch_vccnz k2B_s11
    v_mfma_f32_16x16x32_bf16 v[20:23], v[76:79], v[48:51], v[20:23]
    v_mfma_f32_16x16x32_bf16 v[24:27], v[80:83], v[48:51], v[24:27]
    s_bitset0_b32 s81, 1
k2B_s11:
    s_bitcmp1_b32 s81, 2
    s_cbranch_scc0 k2B_s12
    ds_read_b128 v[52:55], v156 offset:1024
    s_mov_b32 m0, s72
    s_nop 0
    buffer_load_dwordx4 v0, s[16:19], s41 offen offset:1024 sc1 lds
    s_waitcnt lgkmcnt(0)
    v_max3_u32 v5, v52, v53, v54
    v_max_u32 v5, v5, v55
    v_cmp_eq_u32 vcc, -1, v5
    s_cbranch_vccnz k2B_s12
    v_mfma_f32_16x16x32_bf16 v[12:15], v[84:87], v[52:55], v[12:15]
    v_mfma_f32_16x16x32_bf16 v[16:19], v[88:91], v[52:55], v[16:19]
    s_bitset0_b32 s81, 2
k2B_s12:
    s_bitcmp1_b32 s81, 3
    s_cbranch_scc0 k2B_s13
    ds_read_b128 v[56:59], v157 offset:1024
    s_mov_b32 m0, s73
    s_nop 0
    buffer_load_dwordx4 v0, s[16:19], s42 offen offset:1024 sc1 lds
    s_waitcnt lgkmcnt(0)
    v_max3_u32 v5, v56, v57, v58
    v_max_u32 v5, v5, v59
    v_cmp_eq_u32 vcc, -1, v5
    s_cbranch_vccnz k2B_s13
    v_mfma_f32_16x16x32_bf16 v[20:23], v[84:87], v[56:59], v[20:23]
    v_mfma_f32_16x16x32_bf16 v[24:27], v[88:91], v[56:59], v[24:27]
    s_bitset0_b32 s81, 3
k2B_s13:
k2B_g10:
    s_and_b32 s38, s81, 240
    s_cbranch_scc0 k2B_g14
    s_bitcmp1_b32 s81, 4
    s_cbranch_scc0 k2B_s14
    ds_read_b128 v[60:63], v156 offset:2048
    s_mov_b32 m0, s72
    s_nop 0
    buffer_load_dwordx4 v0, s[16:19], s41 offen offset:2048 sc1 lds
    s_waitcnt lgkmcnt(0)
    v_max3_u32 v5, v60, v61, v62
    v_max_u32 v5, v5, v63
    v_cmp_eq_u32 vcc, -1, v5
    s_cbranch_vccnz k2B_s14
    v_mfma_f32_16x16x32_bf16 v[12:15], v[92:95], v[60:63], v[12:15]
    v_mfma_f32_16x16x32_bf16 v[16:19], v[96:99], v[60:63], v[16:19]
    s_bitset0_b32 s81, 4
k2B_s14:
    s_bitcmp1_b32 s81, 5
    s_cbranch_scc0 k2B_s15
    ds_read_b128 v[64:67], v157 offset:2048
    s_mov_b32 m0, s73
    s_nop 0
    buffer_load_dwordx4 v0, s[16:19], s42 offen offset:2048 sc1 lds
    s_waitcnt lgkmcnt(0)
    v_max3_u32 v5, v64, v65, v66
    v_max_u32 v5, v5, v67
    v_cmp_eq_u32 vcc, -1, v5
    s_cbranch_vccnz k2B_s15
    v_mfma_f32_16x16x32_bf16 v[20:23], v[92:95], v[64:67], v[20:23]
    v_mfma_f32_16x16x32_bf16 v[24:27], v[96:99], v[64:67], v[24:27]
    s_bitset0_b32 s81, 5
k2B_s15:
    s_bitcmp1_b32 s81, 6
    s_cbranch_scc0 k2B_s16
    ds_read_b128 v[68:71], v156 offset:3072
    s_mov_b32 m0, s72
    s_nop 0
    buffer_load_dwordx4 v0, s[16:19], s41 offen offset:3072 sc1 lds
    s_waitcnt lgkmcnt(0)
    v_max3_u32 v5, v68, v69, v70
    v_max_u32 v5, v5, v71
    v_cmp_eq_u32 vcc, -1, v5
    s_cbranch_vccnz k2B_s16
    v_mfma_f32_16x16x32_bf16 v[12:15], v[100:103], v[68:71], v[12:15]
    v_mfma_f32_16x16x32_bf16 v[16:19], v[104:107], v[68:71], v[16:19]
    s_bitset0_b32 s81, 6
k2B_s16:
    s_bitcmp1_b32 s81, 7
    s_cbranch_scc0 k2B_s17
    ds_read_b128 v[72:75], v157 offset:3072
    s_mov_b32 m0, s73
    s_nop 0
    buffer_load_dwordx4 v0, s[16:19], s42 offen offset:3072 sc1 lds
    s_waitcnt lgkmcnt(0)
    v_max3_u32 v5, v72, v73, v74
    v_max_u32 v5, v5, v75
    v_cmp_eq_u32 vcc, -1, v5
    s_cbranch_vccnz k2B_s17
    v_mfma_f32_16x16x32_bf16 v[20:23], v[100:103], v[72:75], v[20:23]
    v_mfma_f32_16x16x32_bf16 v[24:27], v[104:107], v[72:75], v[24:27]
    s_bitset0_b32 s81, 7
k2B_s17:
k2B_g14:
    s_and_b32 s38, s81, 768
    s_cbranch_scc0 k2B_g18
    s_bitcmp1_b32 s81, 8
    s_cbranch_scc0 k2B_s18
    ds_read_b64 v[160:161], v158 offset:4096
    ds_read_b64 v[162:163], v158 offset:4608
    s_add_u32 m0, s72, 4096
    s_nop 0
    buffer_load_dwordx4 v0, s[16:19], s43 offen offset:0 sc1 lds
    s_waitcnt lgkmcnt(0)
    v_max3_u32 v5, v160, v161, v162
    v_max_u32 v5, v5, v163
    v_cmp_eq_u32 vcc, -1, v5
    s_cbranch_vccnz k2B_s18
    v_mfma_f32_16x16x32_bf16 v[12:15], v[108:111], v[160:163], v[12:15]
    v_mfma_f32_16x16x32_bf16 v[16:19], v[112:115], v[160:163], v[16:19]
    s_bitset0_b32 s81, 8
k2B_s18:
    s_bitcmp1_b32 s81, 9
    s_cbranch_scc0 k2B_s19
    ds_read_b64 v[164:165], v159 offset:4096
    ds_read_b64 v[166:167], v159 offset:4608
    s_add_u32 m0, s73, 4096
    s_nop 0
    buffer_load_dwordx4 v0, s[16:19], s44 offen offset:0 sc1 lds
    s_waitcnt lgkmcnt(0)
    v_max3_u32 v5, v164, v165, v166
    v_max_u32 v5, v5, v167
    v_cmp_eq_u32 vcc, -1, v5
    s_cbranch_vccnz k2B_s19
    v_mfma_f32_16x16x32_bf16 v[20:23], v[108:111], v[164:167], v[20:23]
    v_mfma_f32_16x16x32_bf16 v[24:27], v[112:115], v[164:167], v[24:27]
    s_bitset0_b32 s81, 9
k2B_s19:
k2B_g18:
    s_cmp_eq_u32 s81, 0
    s_cbranch_scc1 k2B_done
    s_sub_u32 s82, s82, 1
    s_cbranch_scc0 k2B_slow1
    s_branch k2B_done
k2_bad:
    v_mov_b32 v128, 1
    ds_write_b32 v131, v128
    s_waitcnt lgkmcnt(0)
    s_branch k2_okw
k2_second:
    v_min_u32 v160, -2, v160
    v_min_u32 v161, -2, v161
    v_min_u32 v162, -2, v162
    v_min_u32 v163, -2, v163
    v_min_u32 v164, -2, v164
    v_min_u32 v165, -2, v165
    s_branch k2_store
k2_fb:
    s_mov_b32 s34, 1
    s_waitcnt vmcnt(0)
    s_add_u32 s38, s24, 0
    s_and_b32 s38, s38, 3
    s_sub_u32 s38, s38, s24
    s_mul_i32 s38, s38, 81920
    s_add_u32 s39, s42, s38
    s_add_u32 s38, s41, s38
    buffer_load_dwordx4 v[76:79], v0, s[8:11], s38 offen
    s_mov_b64 exec, s[30:31]
    buffer_load_dwordx2 v[92:93], v0, s[8:11], s39 offen
    s_mov_b64 exec, -1
    s_add_u32 s38, s24, 1
    s_and_b32 s38, s38, 3
    s_sub_u32 s38, s38, s24
    s_mul_i32 s38, s38, 81920
    s_add_u32 s39, s42, s38
    s_add_u32 s38, s41, s38
    buffer_load_dwordx4 v[80:83], v0, s[8:11], s38 offen
    s_mov_b64 exec, s[30:31]
    buffer_load_dwordx2 v[94:95], v0, s[8:11], s39 offen
    s_mov_b64 exec, -1
    s_add_u32 s38, s24, 2
    s_and_b32 s38, s38, 3
    s_sub_u32 s38, s38, s24
    s_mul_i32 s38, s38, 81920
    s_add_u32 s39, s42, s38
    s_add_u32 s38, s41, s38
    buffer_load_dwordx4 v[84:87], v0, s[8:11], s38 offen
    s_mov_b64 exec, s[30:31]
    buffer_load_dwordx2 v[96:97], v0, s[8:11], s39 offen
    s_mov_b64 exec, -1
    s_add_u32 s38, s24, 3
    s_and_b32 s38, s38, 3
    s_sub_u32 s38, s38, s24
    s_mul_i32 s38, s38, 81920
    s_add_u32 s39, s42, s38
    s_add_u32 s38, s41, s38
    buffer_load_dwordx4 v[88:91], v0, s[8:11], s38 offen
    s_mov_b64 exec, s[30:31]
    buffer_load_dwordx2 v[98:99], v0, s[8:11], s39 offen
    s_mov_b64 exec, -1
    v_mov_b32 v2, 0x3f803f80
    s_not_b64 exec, s[30:31]
    v_mov_b32 v108, v2
    v_mov_b32 v109, 0x3f80
    v_mov_b32 v110, v2
    v_mov_b32 v111, 0x3f80
    s_not_b64 exec, s[32:33]
    v_cndmask_b32 v112, 0, v2, s[44:45]
    v_cndmask_b32 v113, 0, v2, s[44:45]
    v_cndmask_b32 v114, 0, v2, s[44:45]
    v_cndmask_b32 v115, 0, v2, s[44:45]
    v_cndmask_b32 v116, 0, v2, s[44:45]
    v_cndmask_b32 v117, 0, v2, s[44:45]
    v_cndmask_b32 v118, 0, v2, s[44:45]
    v_cndmask_b32 v119, 0, v2, s[44:45]
    s_mov_b64 exec, -1
    v_cndmask_b32 v120, 0, v2, s[44:45]
    v_cndmask_b32 v121, 0, v2, s[44:45]
    v_cndmask_b32 v122, 0, v2, s[44:45]
    v_cndmask_b32 v123, 0, v2, s[44:45]
    v_cndmask_b32 v124, 0, v2, s[44:45]
    v_cndmask_b32 v125, 0, v2, s[44:45]
    v_cndmask_b32 v126, 0, v2, s[44:45]
    v_cndmask_b32 v127, 0, v2, s[44:45]
    s_waitcnt vmcnt(0)
    v_cndmask_b32 v92, 0, v92, s[30:31]
    v_cndmask_b32 v93, 0, v93, s[30:31]
    v_mov_b32 v164, 0xff800000
    v_cndmask_b32 v94, 0, v94, s[30:31]
    v_cndmask_b32 v95, 0, v95, s[30:31]
    v_mov_b32 v165, 0xff800000
    v_cndmask_b32 v96, 0, v96, s[30:31]
    v_cndmask_b32 v97, 0, v97, s[30:31]
    v_mov_b32 v166, 0xff800000
    v_cndmask_b32 v98, 0, v98, s[30:31]
    v_cndmask_b32 v99, 0, v99, s[30:31]
    v_mov_b32 v167, 0xff800000
    s_mov_b32 s25, s35
    s_mov_b32 s26, s36
    s_mov_b32 s28, 16
k2_fb_loop:
    buffer_load_dwordx4 v[100:103], v0, s[8:11], s25 offen
    s_mov_b64 exec, s[30:31]
    buffer_load_dwordx2 v[108:109], v0, s[8:11], s26 offen
    s_mov_b64 exec, -1
    s_add_u32 s25, s25, 81920
    s_add_u32 s26, s26, 81920
    s_waitcnt vmcnt(0)
    v_mfma_f32_32x32x16_bf16 v[12:27], v[100:103], v[76:79], 0
    v_mfma_f32_32x32x16_bf16 v[28:43], v[100:103], v[80:83], 0
    v_mfma_f32_32x32x16_bf16 v[44:59], v[100:103], v[84:87], 0
    v_mfma_f32_32x32x16_bf16 v[60:75], v[100:103], v[88:91], 0
    v_mfma_f32_32x32x8_bf16 v[12:27], v[108:109], v[92:93], v[12:27]
    v_mfma_f32_32x32x8_bf16 v[28:43], v[108:109], v[94:95], v[28:43]
    v_mfma_f32_32x32x8_bf16 v[44:59], v[108:109], v[96:97], v[44:59]
    v_mfma_f32_32x32x8_bf16 v[60:75], v[108:109], v[98:99], v[60:75]
    s_nop 7
    s_nop 3
    v_max3_f32 v164, v164, v12, v13
    v_max3_f32 v164, v164, v14, v15
    v_max3_f32 v164, v164, v16, v17
    v_max3_f32 v164, v164, v18, v19
    v_max3_f32 v164, v164, v20, v21
    v_max3_f32 v164, v164, v22, v23
    v_max3_f32 v164, v164, v24, v25
    v_max3_f32 v164, v164, v26, v27
    v_max3_f32 v165, v165, v28, v29
    v_max3_f32 v165, v165, v30, v31
    v_max3_f32 v165, v165, v32, v33
    v_max3_f32 v165, v165, v34, v35
    v_max3_f32 v165, v165, v36, v37
    v_max3_f32 v165, v165, v38, v39
    v_max3_f32 v165, v165, v40, v41
    v_max3_f32 v165, v165, v42, v43
    v_max3_f32 v166, v166, v44, v45
    v_max3_f32 v166, v166, v46, v47
    v_max3_f32 v166, v166, v48, v49
    v_max3_f32 v166, v166, v50, v51
    v_max3_f32 v166, v166, v52, v53
    v_max3_f32 v166, v166, v54, v55
    v_max3_f32 v166, v166, v56, v57
    v_max3_f32 v166, v166, v58, v59
    v_max3_f32 v167, v167, v60, v61
    v_max3_f32 v167, v167, v62, v63
    v_max3_f32 v167, v167, v64, v65
    v_max3_f32 v167, v167, v66, v67
    v_max3_f32 v167, v167, v68, v69
    v_max3_f32 v167, v167, v70, v71
    v_max3_f32 v167, v167, v72, v73
    v_max3_f32 v167, v167, v74, v75
    s_sub_u32 s28, s28, 1
    s_cmp_lg_u32 s28, 0
    s_cbranch_scc1 k2_fb_loop
    v_lshrrev_b32 v3, 2, v0
    s_lshl_b32 s39, s23, 12
    s_add_u32 s39, s39, 0
    s_lshl_b32 s40, s24, 10
    s_add_u32 s38, s24, 0
    s_and_b32 s38, s38, 3
    s_lshl_b32 s38, s38, 8
    s_add_u32 s38, s38, s39
    v_add_u32 v152, s38, v3
    v_add_u32 v2, s40, v152
    ds_write_b32 v2, v164
    s_add_u32 s38, s24, 1
    s_and_b32 s38, s38, 3
    s_lshl_b32 s38, s38, 8
    s_add_u32 s38, s38, s39
    v_add_u32 v153, s38, v3
    v_add_u32 v2, s40, v153
    ds_write_b32 v2, v165
    s_add_u32 s38, s24, 2
    s_and_b32 s38, s38, 3
    s_lshl_b32 s38, s38, 8
    s_add_u32 s38, s38, s39
    v_add_u32 v154, s38, v3
    v_add_u32 v2, s40, v154
    ds_write_b32 v2, v166
    s_add_u32 s38, s24, 3
    s_and_b32 s38, s38, 3
    s_lshl_b32 s38, s38, 8
    s_add_u32 s38, s38, s39
    v_add_u32 v155, s38, v3
    v_add_u32 v2, s40, v155
    ds_write_b32 v2, v167
    s_waitcnt lgkmcnt(0)
    s_barrier
    ds_read_b32 v12, v152 offset:0
    ds_read_b32 v16, v152 offset:1024
    ds_read_b32 v20, v152 offset:2048
    ds_read_b32 v24, v152 offset:3072
    ds_read_b32 v13, v153 offset:0
    ds_read_b32 v17, v153 offset:1024
    ds_read_b32 v21, v153 offset:2048
    ds_read_b32 v25, v153 offset:3072
    ds_read_b32 v14, v154 offset:0
    ds_read_b32 v18, v154 offset:1024
    ds_read_b32 v22, v154 offset:2048
    ds_read_b32 v26, v154 offset:3072
    ds_read_b32 v15, v155 offset:0
    ds_read_b32 v19, v155 offset:1024
    ds_read_b32 v23, v155 offset:2048
    ds_read_b32 v27, v155 offset:3072
    s_waitcnt lgkmcnt(0)
    s_barrier
    v_max3_f32 v164, v12, v16, v20
    v_max_f32 v164, v164, v24
    v_max3_f32 v165, v13, v17, v21
    v_max_f32 v165, v165, v25
    v_max3_f32 v166, v14, v18, v22
    v_max_f32 v166, v166, v26
    v_max3_f32 v167, v15, v19, v23
    v_max_f32 v167, v167, v27
    v_mov_b32 v144, v164
    v_mov_b32 v145, v165
    v_mov_b32 v146, v166
    v_mov_b32 v147, v167
    s_nop 1
    v_permlane32_swap_b32 v164, v144
    v_permlane32_swap_b32 v165, v145
    v_permlane32_swap_b32 v166, v146
    v_permlane32_swap_b32 v167, v147
    v_max_f32 v164, v164, v144
    v_max_f32 v165, v165, v145
    v_max_f32 v166, v166, v146
    v_max_f32 v167, v167, v147
    v_sub_f32 v164, 0x80000000, v164
    v_sub_f32 v165, 0x80000000, v165
    v_sub_f32 v166, 0x80000000, v166
    v_sub_f32 v167, 0x80000000, v167
    v_and_b32 v144, 0xffff0000, v164
    v_and_b32 v145, 0xffff0000, v165
    v_and_b32 v146, 0xffff0000, v166
    v_and_b32 v147, 0xffff0000, v167
    v_sub_f32 v164, v164, v144
    v_sub_f32 v165, v165, v145
    v_sub_f32 v166, v166, v146
    v_sub_f32 v167, v167, v147
    v_and_b32 v148, 0xffff0000, v164
    v_and_b32 v149, 0xffff0000, v165
    v_and_b32 v150, 0xffff0000, v166
    v_and_b32 v151, 0xffff0000, v167
    v_sub_f32 v164, v164, v148
    v_sub_f32 v165, v165, v149
    v_sub_f32 v166, v166, v150
    v_sub_f32 v167, v167, v151
    v_lshrrev_b32 v144, 16, v144
    v_lshrrev_b32 v145, 16, v145
    v_lshrrev_b32 v146, 16, v146
    v_lshrrev_b32 v147, 16, v147
    v_or_b32 v144, v144, v148
    v_or_b32 v145, v145, v149
    v_or_b32 v146, v146, v150
    v_or_b32 v147, v147, v151
    v_lshrrev_b32 v164, 16, v164
    v_lshrrev_b32 v165, 16, v165
    v_lshrrev_b32 v166, 16, v166
    v_lshrrev_b32 v167, 16, v167
    v_cndmask_b32 v92, v144, v92, s[30:31]
    v_cndmask_b32 v94, v145, v94, s[30:31]
    v_cndmask_b32 v96, v146, v96, s[30:31]
    v_cndmask_b32 v98, v147, v98, s[30:31]
    v_cndmask_b32 v93, v164, v93, s[30:31]
    v_cndmask_b32 v95, v165, v95, s[30:31]
    v_cndmask_b32 v97, v166, v97, s[30:31]
    v_cndmask_b32 v99, v167, v99, s[30:31]
    s_mov_b32 s25, s35
    s_mov_b32 s26, s36
    s_mov_b32 s27, s37
    s_add_u32 s29, s37, 20480
    buffer_load_dwordx4 v[100:103], v0, s[8:11], s25 offen
    s_mov_b64 exec, s[30:31]
    buffer_load_dwordx2 v[108:109], v0, s[8:11], s26 offen
    s_mov_b64 exec, -1
    s_mov_b64 exec, s[32:33]
    buffer_load_dwordx4 v[112:115], v1, s[12:15], s27 offen
    buffer_load_dwordx4 v[116:119], v1, s[12:15], s29 offen
    s_mov_b64 exec, -1
    s_add_u32 s25, s25, 81920
    s_add_u32 s26, s26, 81920
    s_add_u32 s27, s27, 40960
    s_add_u32 s29, s29, 40960
    buffer_load_dwordx4 v[104:107], v0, s[8:11], s25 offen
    s_mov_b64 exec, s[30:31]
    buffer_load_dwordx2 v[110:111], v0, s[8:11], s26 offen
    s_mov_b64 exec, -1
    v_and_b32 v2, s72, v0
    v_and_b32 v3, s73, v0
    v_and_b32 v160, s74, v0
    v_lshl_or_b32 v2, v3, 1, v2
    v_lshl_or_b32 v2, v160, 3, v2
    v_add_u32 v3, s76, v2
    v_add_u32 v2, s75, v2
    s_branch k2_run
k2_fin:
k2_exit:
    s_endpgm
k2_gemm:
    s_setprio 0
    s_sub_u32 s23, s20, 8
    s_and_b32 s24, s2, 7
    s_lshl_b32 s24, s24, 3
    s_add_u32 s24, s24, s22
    s_bfe_u32 s25, s2, 0x20003
    v_lshrrev_b32 v2, 5, v5
    s_and_b32 s39, s23, 1
    s_lshl_b32 s39, s39, 9
    v_lshl_add_u32 v2, v2, 8, s39
    v_bfe_u32 v3, v5, 4, 1
    v_mul_u32_u24 v3, 55296, v3
    v_and_b32 v4, 15, v5
    v_lshl_add_u32 v3, v4, 4, v3
    v_add_u32 v150, v2, v3
    s_lshl_b32 s39, s23, 3
    v_add_u32 v3, s39, v5
    v_bfe_u32 v4, v3, 4, 1
    v_lshl_add_u32 v2, v4, 10, v2
    v_and_b32 v3, 15, v3
    v_lshl_add_u32 v151, v3, 4, v2
    s_lshr_b32 s39, s23, 1
    s_mul_i32 s26, s24, 110592
    s_lshl_b32 s40, s39, 10
    s_add_u32 s26, s26, s40
    s_mul_i32 s27, s39, 40960
    s_mul_i32 s40, s25, 10240
    s_add_u32 s27, s27, s40
    s_waitcnt lgkmcnt(0)
    s_add_u32 s12, s4, 7864320
    s_addc_u32 s13, s5, 0
    s_mov_b32 s14, 7077888
    s_mov_b32 s15, 0x00020000
    s_add_u32 s16, s4, 17563648
    s_addc_u32 s17, s5, 0
    s_mov_b32 s18, 3031040
    s_mov_b32 s19, 0x00020000
    v_mov_b32 v140, 0
    v_mov_b32 v141, 0
    v_mov_b32 v142, 0
    v_mov_b32 v143, 0
    v_and_b32 v2, 31, v5
    v_mul_u32_u24 v2, 1280, v2
    v_lshrrev_b32 v3, 5, v5
    v_lshl_add_u32 v152, v3, 3, v2
    s_mul_i32 s28, s24, 40960
    s_mul_i32 s38, s25, 320
    s_add_u32 s28, s28, s38
    s_lshl_b32 s38, s23, 4
    s_add_u32 s28, s28, s38
    v_mfma_f32_32x32x16_bf16 v[12:27], v[140:143], v[140:143], 0
    v_mfma_f32_32x32x16_bf16 v[28:43], v[140:143], v[140:143], 0
    v_mfma_f32_32x32x16_bf16 v[44:59], v[140:143], v[140:143], 0
    v_mfma_f32_32x32x16_bf16 v[60:75], v[140:143], v[140:143], 0
    v_mfma_f32_32x32x16_bf16 v[76:91], v[140:143], v[140:143], 0
    v_add_u32 v154, 4096, v151
    v_add_u32 v155, 8192, v151
    s_barrier
    buffer_load_dwordx4 v[128:131], v150, s[12:15], s26 offen
    s_add_u32 s26, s26, 2048
    buffer_load_dwordx4 v[92:95], v151, s[16:19], s27 offen offset:0
    buffer_load_dwordx4 v[96:99], v151, s[16:19], s27 offen offset:2048
    buffer_load_dwordx4 v[100:103], v154, s[16:19], s27 offen offset:0
    buffer_load_dwordx4 v[104:107], v154, s[16:19], s27 offen offset:2048
    buffer_load_dwordx4 v[132:135], v150, s[12:15], s26 offen
    s_add_u32 s26, s26, 2048
    buffer_load_dwordx4 v[108:111], v155, s[16:19], s27 offen offset:0
    s_add_u32 s27, s27, 81920
    buffer_load_dwordx4 v[112:115], v151, s[16:19], s27 offen offset:0
    buffer_load_dwordx4 v[116:119], v151, s[16:19], s27 offen offset:2048
    buffer_load_dwordx4 v[120:123], v154, s[16:19], s27 offen offset:0
    buffer_load_dwordx4 v[124:127], v154, s[16:19], s27 offen offset:2048
    buffer_load_dwordx4 v[136:139], v150, s[12:15], s26 offen
    s_add_u32 s26, s26, 2048
    s_and_b32 s78, s20, 3
    s_and_b32 s80, s20, 1
    s_bfe_u32 s79, s20, 0x10001
    s_mul_i32 s77, s78, 163840
    s_mul_i32 s86, s78, 122880
    s_sub_u32 s86, 655360, s86
    s_bfe_u32 s38, s2, 0x20003
    s_mul_i32 s38, s38, 10240
    s_add_u32 s77, s77, s38
    s_add_u32 s77, s77, 2211840
    s_add_u32 s38, s23, 1
    s_and_b32 s38, s38, 3
    s_mul_i32 s38, s38, 15360
    s_add_u32 s45, s38, 73728
    s_add_u32 s38, s23, 2
    s_and_b32 s38, s38, 3
    s_mul_i32 s38, s38, 15360
    s_add_u32 s46, s38, 78848
    s_add_u32 s38, s23, 3
    s_and_b32 s38, s38, 3
    s_mul_i32 s38, s38, 15360
    s_add_u32 s47, s38, 83968
    v_and_b32 v164, 0x330, v0
    v_and_b32 v3, 64, v0
    v_and_b32 v4, 0x80, v0
    v_lshl_or_b32 v164, v3, 1, v164
    v_lshl_or_b32 v164, v4, 3, v164
    v_add_u32 v165, 64, v164
    s_lshl_b32 s39, s80, 11
    s_xor_b32 s40, s39, 2048
    s_add_u32 s75, s77, s40
    s_add_u32 s48, s77, 6144
    s_add_u32 s49, s48, s40
    s_add_u32 s48, s48, s39
    s_mul_i32 s38, s23, 15360
    s_add_u32 s76, s38, 73728
    s_add_u32 s68, s4, 14942208
    s_addc_u32 s69, s5, 0
    s_mov_b32 s70, 2621440
    s_mov_b32 s71, 0x00020000
    s_mov_b32 s60, s64
    s_mov_b32 s61, s65
    s_mov_b32 s62, 2621440
    s_mov_b32 s63, 0x00020000
    s_mul_i32 s39, s78, 10240
    s_mul_i32 s40, s79, 5120
    s_add_u32 s72, s39, s40
    s_sub_u32 s73, s39, s40
    s_add_u32 s73, s73, 5120
    s_and_b32 s38, s2, 7
    s_lshl_b32 s38, s38, 3
    s_add_u32 s38, s38, s22
    s_lshl1_add_u32 s38, s38, s79
    s_mul_i32 s41, s38, 20480
    s_xor_b32 s38, s38, 1
    s_mul_i32 s42, s38, 20480
    s_lshl_b32 s38, s78, 10
    s_add_u32 s38, s38, 16384
    s_add_u32 s43, s41, s38
    s_add_u32 s44, s42, s38
    s_lshl_b32 s38, s78, 12
    s_add_u32 s41, s41, s38
    s_add_u32 s42, s42, s38
    v_and_b32 v4, 0xf0, v0
    v_lshrrev_b32 v2, 8, v0
    s_lshl_b32 s38, s80, 10
    s_lshl_b32 s39, s79, 8
    s_add_u32 s38, s38, s39
    s_add_u32 s38, s38, 76800
    v_add_u32 v1, s38, v4
    v_mul_u32_u24 v3, 15360, v2
    v_add_u32 v1, v1, v3
    v_mul_u32_u24 v4, 80, v4
    v_lshl_add_u32 v4, v2, 4, v4
    s_xor_b32 s38, s78, 1
    s_mul_i32 s38, s38, 6144
    s_add_u32 s38, s38, 40960
    v_add_u32 v6, s38, v0
    s_xor_b32 s38, s78, 2
    s_mul_i32 s38, s38, 6144
    s_add_u32 s38, s38, 43008
    v_add_u32 v7, s38, v0
    s_xor_b32 s38, s78, 3
    s_mul_i32 s38, s38, 6144
    s_add_u32 s38, s38, 45056
    v_add_u32 v8, s38, v0
    s_mul_i32 s38, s78, 6144
    s_add_u32 s38, s38, 40960
    v_add_u32 v9, s38, v0
    s_and_b32 s87, s2, 7
    s_lshl_b32 s87, s87, 3
    s_add_u32 s87, s87, s22
    s_lshl1_add_u32 s87, s87, s79
    s_mul_i32 s87, s87, 20480
    s_bfe_u32 s38, s2, 0x20003
    s_mul_i32 s38, s38, 320
    s_add_u32 s87, s87, s38
    s_lshl_b32 s38, s80, 6
    s_add_u32 s87, s87, s38
    s_add_u32 s87, s87, 192
    s_movk_i32 s81, 0x3ff
    s_mov_b32 s82, 400000
    v_add_u32 v2, s76, v0
    v_mov_b32 v3, 135168
    s_mov_b32 s8, s6
    s_mov_b32 s9, s7
    s_mov_b32 s10, 2621440
    s_mov_b32 s11, 0x00020000
    s_add_u32 s52, s4, 23789568
    s_addc_u32 s53, s5, 0
    s_mov_b32 s54, 8192
    s_mov_b32 s55, 0x00020000
    v_and_b32 v166, 31, v5
    v_lshlrev_b32 v166, 2, v166
    s_lshl_b32 s29, s24, 7
    s_mov_b32 s30, 3
    s_setprio 0
    s_barrier
    buffer_load_dwordx2 v[140:141], v152, s[8:11], s28 offen offset:0
    buffer_load_dwordx2 v[142:143], v152, s[8:11], s28 offen offset:64
    buffer_load_dwordx2 v[144:145], v152, s[8:11], s28 offen offset:128
    buffer_load_dwordx2 v[146:147], v152, s[8:11], s28 offen offset:192
    buffer_load_dwordx2 v[148:149], v152, s[8:11], s28 offen offset:256
    buffer_load_dword v166, v166, s[52:55], s29 offen
    s_setprio 0
.p2align 6
k2_gloop:
    s_waitcnt vmcnt(10)
    v_mfma_f32_32x32x16_bf16 v[12:27], v[92:95], v[128:131], v[12:27]
    buffer_load_dwordx4 v[92:95], v155, s[16:19], s27 offen offset:0
    s_add_u32 s27, s27, 81920
    s_waitcnt vmcnt(10)
    v_mfma_f32_32x32x16_bf16 v[28:43], v[96:99], v[128:131], v[28:43]
    buffer_load_dwordx4 v[96:99], v151, s[16:19], s27 offen offset:0
    s_waitcnt vmcnt(10)
    v_mfma_f32_32x32x16_bf16 v[44:59], v[100:103], v[128:131], v[44:59]
    buffer_load_dwordx4 v[100:103], v151, s[16:19], s27 offen offset:2048
    s_waitcnt vmcnt(10)
    v_mfma_f32_32x32x16_bf16 v[60:75], v[104:107], v[128:131], v[60:75]
    buffer_load_dwordx4 v[104:107], v154, s[16:19], s27 offen offset:0
    s_waitcnt vmcnt(9)
    v_mfma_f32_32x32x16_bf16 v[76:91], v[108:111], v[128:131], v[76:91]
    buffer_load_dwordx4 v[108:111], v154, s[16:19], s27 offen offset:2048
    buffer_load_dwordx4 v[128:131], v150, s[12:15], s26 offen
    s_add_u32 s26, s26, 2048
    s_waitcnt vmcnt(10)
    v_mfma_f32_32x32x16_bf16 v[12:27], v[112:115], v[132:135], v[12:27]
    buffer_load_dwordx4 v[112:115], v155, s[16:19], s27 offen offset:0
    s_add_u32 s27, s27, 81920
    s_waitcnt vmcnt(10)
    v_mfma_f32_32x32x16_bf16 v[28:43], v[116:119], v[132:135], v[28:43]
    buffer_load_dwordx4 v[116:119], v151, s[16:19], s27 offen offset:0
    s_waitcnt vmcnt(10)
    v_mfma_f32_32x32x16_bf16 v[44:59], v[120:123], v[132:135], v[44:59]
    buffer_load_dwordx4 v[120:123], v151, s[16:19], s27 offen offset:2048
    s_waitcnt vmcnt(10)
    v_mfma_f32_32x32x16_bf16 v[60:75], v[124:127], v[132:135], v[60:75]
    buffer_load_dwordx4 v[124:127], v154, s[16:19], s27 offen offset:0
    s_waitcnt vmcnt(9)
    v_mfma_f32_32x32x16_bf16 v[76:91], v[92:95], v[132:135], v[76:91]
    buffer_load_dwordx4 v[92:95], v154, s[16:19], s27 offen offset:2048
    buffer_load_dwordx4 v[132:135], v150, s[12:15], s26 offen
    s_add_u32 s26, s26, 2048
    s_waitcnt vmcnt(10)
    v_mfma_f32_32x32x16_bf16 v[12:27], v[96:99], v[136:139], v[12:27]
    buffer_load_dwordx4 v[96:99], v155, s[16:19], s27 offen offset:0
    s_add_u32 s27, s27, 81920
    s_waitcnt vmcnt(10)
    v_mfma_f32_32x32x16_bf16 v[28:43], v[100:103], v[136:139], v[28:43]
    buffer_load_dwordx4 v[100:103], v151, s[16:19], s27 offen offset:0
    s_waitcnt vmcnt(10)
    v_mfma_f32_32x32x16_bf16 v[44:59], v[104:107], v[136:139], v[44:59]
    buffer_load_dwordx4 v[104:107], v151, s[16:19], s27 offen offset:2048
    s_waitcnt vmcnt(10)
    v_mfma_f32_32x32x16_bf16 v[60:75], v[108:111], v[136:139], v[60:75]
    buffer_load_dwordx4 v[108:111], v154, s[16:19], s27 offen offset:0
    s_waitcnt vmcnt(9)
    v_mfma_f32_32x32x16_bf16 v[76:91], v[112:115], v[136:139], v[76:91]
    buffer_load_dwordx4 v[112:115], v154, s[16:19], s27 offen offset:2048
    buffer_load_dwordx4 v[136:139], v150, s[12:15], s26 offen
    s_add_u32 s26, s26, 2048
    s_waitcnt vmcnt(10)
    v_mfma_f32_32x32x16_bf16 v[12:27], v[116:119], v[128:131], v[12:27]
    buffer_load_dwordx4 v[116:119], v155, s[16:19], s27 offen offset:0
    s_add_u32 s27, s27, 81920
    s_waitcnt vmcnt(10)
    v_mfma_f32_32x32x16_bf16 v[28:43], v[120:123], v[128:131], v[28:43]
    buffer_load_dwordx4 v[120:123], v151, s[16:19], s27 offen offset:0
    s_waitcnt vmcnt(10)
    v_mfma_f32_32x32x16_bf16 v[44:59], v[124:127], v[128:131], v[44:59]
    buffer_load_dwordx4 v[124:127], v151, s[16:19], s27 offen offset:2048
    s_waitcnt vmcnt(10)
    v_mfma_f32_32x32x16_bf16 v[60:75], v[92:95], v[128:131], v[60:75]
    buffer_load_dwordx4 v[92:95], v154, s[16:19], s27 offen offset:0
    s_waitcnt vmcnt(9)
    v_mfma_f32_32x32x16_bf16 v[76:91], v[96:99], v[128:131], v[76:91]
    buffer_load_dwordx4 v[96:99], v154, s[16:19], s27 offen offset:2048
    buffer_load_dwordx4 v[128:131], v150, s[12:15], s26 offen
    s_add_u32 s26, s26, 2048
    s_waitcnt vmcnt(10)
    v_mfma_f32_32x32x16_bf16 v[12:27], v[100:103], v[132:135], v[12:27]
    buffer_load_dwordx4 v[100:103], v155, s[16:19], s27 offen offset:0
    s_add_u32 s27, s27, 81920
    s_waitcnt vmcnt(10)
    v_mfma_f32_32x32x16_bf16 v[28:43], v[104:107], v[132:135], v[28:43]
    buffer_load_dwordx4 v[104:107], v151, s[16:19], s27 offen offset:0
    s_waitcnt vmcnt(10)
    v_mfma_f32_32x32x16_bf16 v[44:59], v[108:111], v[132:135], v[44:59]
    buffer_load_dwordx4 v[108:111], v151, s[16:19], s27 offen offset:2048
    s_waitcnt vmcnt(10)
    v_mfma_f32_32x32x16_bf16 v[60:75], v[112:115], v[132:135], v[60:75]
    buffer_load_dwordx4 v[112:115], v154, s[16:19], s27 offen offset:0
    s_waitcnt vmcnt(9)
    v_mfma_f32_32x32x16_bf16 v[76:91], v[116:119], v[132:135], v[76:91]
    buffer_load_dwordx4 v[116:119], v154, s[16:19], s27 offen offset:2048
    buffer_load_dwordx4 v[132:135], v150, s[12:15], s26 offen
    s_add_u32 s26, s26, 2048
    s_waitcnt vmcnt(10)
    v_mfma_f32_32x32x16_bf16 v[12:27], v[120:123], v[136:139], v[12:27]
    buffer_load_dwordx4 v[120:123], v155, s[16:19], s27 offen offset:0
    s_add_u32 s27, s27, 81920
    s_waitcnt vmcnt(10)
    v_mfma_f32_32x32x16_bf16 v[28:43], v[124:127], v[136:139], v[28:43]
    buffer_load_dwordx4 v[124:127], v151, s[16:19], s27 offen offset:0
    s_waitcnt vmcnt(10)
    v_mfma_f32_32x32x16_bf16 v[44:59], v[92:95], v[136:139], v[44:59]
    buffer_load_dwordx4 v[92:95], v151, s[16:19], s27 offen offset:2048
    s_waitcnt vmcnt(10)
    v_mfma_f32_32x32x16_bf16 v[60:75], v[96:99], v[136:139], v[60:75]
    buffer_load_dwordx4 v[96:99], v154, s[16:19], s27 offen offset:0
    s_waitcnt vmcnt(9)
    v_mfma_f32_32x32x16_bf16 v[76:91], v[100:103], v[136:139], v[76:91]
    buffer_load_dwordx4 v[100:103], v154, s[16:19], s27 offen offset:2048
    buffer_load_dwordx4 v[136:139], v150, s[12:15], s26 offen
    s_add_u32 s26, s26, 2048
    s_waitcnt vmcnt(10)
    v_mfma_f32_32x32x16_bf16 v[12:27], v[104:107], v[128:131], v[12:27]
    buffer_load_dwordx4 v[104:107], v155, s[16:19], s27 offen offset:0
    s_add_u32 s27, s27, 81920
    s_waitcnt vmcnt(10)
    v_mfma_f32_32x32x16_bf16 v[28:43], v[108:111], v[128:131], v[28:43]
    buffer_load_dwordx4 v[108:111], v151, s[16:19], s27 offen offset:0
    s_waitcnt vmcnt(10)
    v_mfma_f32_32x32x16_bf16 v[44:59], v[112:115], v[128:131], v[44:59]
    buffer_load_dwordx4 v[112:115], v151, s[16:19], s27 offen offset:2048
    s_waitcnt vmcnt(10)
    v_mfma_f32_32x32x16_bf16 v[60:75], v[116:119], v[128:131], v[60:75]
    buffer_load_dwordx4 v[116:119], v154, s[16:19], s27 offen offset:0
    s_waitcnt vmcnt(9)
    v_mfma_f32_32x32x16_bf16 v[76:91], v[120:123], v[128:131], v[76:91]
    buffer_load_dwordx4 v[120:123], v154, s[16:19], s27 offen offset:2048
    buffer_load_dwordx4 v[128:131], v150, s[12:15], s26 offen
    s_add_u32 s26, s26, 2048
    s_waitcnt vmcnt(10)
    v_mfma_f32_32x32x16_bf16 v[12:27], v[124:127], v[132:135], v[12:27]
    buffer_load_dwordx4 v[124:127], v155, s[16:19], s27 offen offset:0
    s_add_u32 s27, s27, 81920
    s_waitcnt vmcnt(10)
    v_mfma_f32_32x32x16_bf16 v[28:43], v[92:95], v[132:135], v[28:43]
    buffer_load_dwordx4 v[92:95], v151, s[16:19], s27 offen offset:0
    s_waitcnt vmcnt(10)
    v_mfma_f32_32x32x16_bf16 v[44:59], v[96:99], v[132:135], v[44:59]
    buffer_load_dwordx4 v[96:99], v151, s[16:19], s27 offen offset:2048
    s_waitcnt vmcnt(10)
    v_mfma_f32_32x32x16_bf16 v[60:75], v[100:103], v[132:135], v[60:75]
    buffer_load_dwordx4 v[100:103], v154, s[16:19], s27 offen offset:0
    s_waitcnt vmcnt(9)
    v_mfma_f32_32x32x16_bf16 v[76:91], v[104:107], v[132:135], v[76:91]
    buffer_load_dwordx4 v[104:107], v154, s[16:19], s27 offen offset:2048
    buffer_load_dwordx4 v[132:135], v150, s[12:15], s26 offen
    s_add_u32 s26, s26, 2048
    s_waitcnt vmcnt(10)
    v_mfma_f32_32x32x16_bf16 v[12:27], v[108:111], v[136:139], v[12:27]
    buffer_load_dwordx4 v[108:111], v155, s[16:19], s27 offen offset:0
    s_add_u32 s27, s27, 81920
    s_waitcnt vmcnt(10)
    v_mfma_f32_32x32x16_bf16 v[28:43], v[112:115], v[136:139], v[28:43]
    buffer_load_dwordx4 v[112:115], v151, s[16:19], s27 offen offset:0
    s_waitcnt vmcnt(10)
    v_mfma_f32_32x32x16_bf16 v[44:59], v[116:119], v[136:139], v[44:59]
    buffer_load_dwordx4 v[116:119], v151, s[16:19], s27 offen offset:2048
    s_waitcnt vmcnt(10)
    v_mfma_f32_32x32x16_bf16 v[60:75], v[120:123], v[136:139], v[60:75]
    buffer_load_dwordx4 v[120:123], v154, s[16:19], s27 offen offset:0
    s_waitcnt vmcnt(9)
    v_mfma_f32_32x32x16_bf16 v[76:91], v[124:127], v[136:139], v[76:91]
    buffer_load_dwordx4 v[124:127], v154, s[16:19], s27 offen offset:2048
    buffer_load_dwordx4 v[136:139], v150, s[12:15], s26 offen
    s_add_u32 s26, s26, 2048
    s_sub_u32 s30, s30, 1
    s_cmp_lg_u32 s30, 1
    s_cbranch_scc1 k2_gloop
    s_waitcnt vmcnt(10)
    v_mfma_f32_32x32x16_bf16 v[12:27], v[92:95], v[128:131], v[12:27]
    buffer_load_dwordx4 v[92:95], v155, s[16:19], s27 offen offset:0
    s_add_u32 s27, s27, 81920
    s_waitcnt vmcnt(10)
    v_mfma_f32_32x32x16_bf16 v[28:43], v[96:99], v[128:131], v[28:43]
    buffer_load_dwordx4 v[96:99], v151, s[16:19], s27 offen offset:0
    s_waitcnt vmcnt(10)
    v_mfma_f32_32x32x16_bf16 v[44:59], v[100:103], v[128:131], v[44:59]
    buffer_load_dwordx4 v[100:103], v151, s[16:19], s27 offen offset:2048
    s_waitcnt vmcnt(10)
    v_mfma_f32_32x32x16_bf16 v[60:75], v[104:107], v[128:131], v[60:75]
    buffer_load_dwordx4 v[104:107], v154, s[16:19], s27 offen offset:0
    s_waitcnt vmcnt(9)
    v_mfma_f32_32x32x16_bf16 v[76:91], v[108:111], v[128:131], v[76:91]
    buffer_load_dwordx4 v[108:111], v154, s[16:19], s27 offen offset:2048
    buffer_load_dwordx4 v[128:131], v150, s[12:15], s26 offen
    s_add_u32 s26, s26, 2048
    s_waitcnt vmcnt(10)
    v_mfma_f32_32x32x16_bf16 v[12:27], v[112:115], v[132:135], v[12:27]
    buffer_load_dwordx4 v[112:115], v155, s[16:19], s27 offen offset:0
    s_add_u32 s27, s27, 81920
    s_waitcnt vmcnt(10)
    v_mfma_f32_32x32x16_bf16 v[28:43], v[116:119], v[132:135], v[28:43]
    buffer_load_dwordx4 v[116:119], v151, s[16:19], s27 offen offset:0
    s_waitcnt vmcnt(10)
    v_mfma_f32_32x32x16_bf16 v[44:59], v[120:123], v[132:135], v[44:59]
    buffer_load_dwordx4 v[120:123], v151, s[16:19], s27 offen offset:2048
    s_waitcnt vmcnt(10)
    v_mfma_f32_32x32x16_bf16 v[60:75], v[124:127], v[132:135], v[60:75]
    buffer_load_dwordx4 v[124:127], v154, s[16:19], s27 offen offset:0
    s_waitcnt vmcnt(9)
    v_mfma_f32_32x32x16_bf16 v[76:91], v[92:95], v[132:135], v[76:91]
    buffer_load_dwordx4 v[92:95], v154, s[16:19], s27 offen offset:2048
    buffer_load_dwordx4 v[132:135], v150, s[12:15], s26 offen
    s_add_u32 s26, s26, 2048
    s_waitcnt vmcnt(10)
    v_mfma_f32_32x32x16_bf16 v[12:27], v[96:99], v[136:139], v[12:27]
    buffer_load_dwordx4 v[96:99], v155, s[16:19], s27 offen offset:0
    s_add_u32 s27, s27, 81920
    s_waitcnt vmcnt(10)
    v_mfma_f32_32x32x16_bf16 v[28:43], v[100:103], v[136:139], v[28:43]
    buffer_load_dwordx4 v[100:103], v151, s[16:19], s27 offen offset:0
    s_waitcnt vmcnt(10)
    v_mfma_f32_32x32x16_bf16 v[44:59], v[104:107], v[136:139], v[44:59]
    buffer_load_dwordx4 v[104:107], v151, s[16:19], s27 offen offset:2048
    s_waitcnt vmcnt(10)
    v_mfma_f32_32x32x16_bf16 v[60:75], v[108:111], v[136:139], v[60:75]
    buffer_load_dwordx4 v[108:111], v154, s[16:19], s27 offen offset:0
    s_waitcnt vmcnt(9)
    v_mfma_f32_32x32x16_bf16 v[76:91], v[112:115], v[136:139], v[76:91]
    buffer_load_dwordx4 v[112:115], v154, s[16:19], s27 offen offset:2048
    buffer_load_dwordx4 v[136:139], v150, s[12:15], s26 offen
    s_add_u32 s26, s26, 2048
    s_waitcnt vmcnt(10)
    v_mfma_f32_32x32x16_bf16 v[12:27], v[116:119], v[128:131], v[12:27]
    buffer_load_dwordx4 v[116:119], v155, s[16:19], s27 offen offset:0
    s_add_u32 s27, s27, 81920
    s_waitcnt vmcnt(10)
    v_mfma_f32_32x32x16_bf16 v[28:43], v[120:123], v[128:131], v[28:43]
    buffer_load_dwordx4 v[120:123], v151, s[16:19], s27 offen offset:0
    s_waitcnt vmcnt(10)
    v_mfma_f32_32x32x16_bf16 v[44:59], v[124:127], v[128:131], v[44:59]
    buffer_load_dwordx4 v[124:127], v151, s[16:19], s27 offen offset:2048
    s_waitcnt vmcnt(10)
    v_mfma_f32_32x32x16_bf16 v[60:75], v[92:95], v[128:131], v[60:75]
    buffer_load_dwordx4 v[92:95], v154, s[16:19], s27 offen offset:0
    s_waitcnt vmcnt(9)
    v_mfma_f32_32x32x16_bf16 v[76:91], v[96:99], v[128:131], v[76:91]
    buffer_load_dwordx4 v[96:99], v154, s[16:19], s27 offen offset:2048
    buffer_load_dwordx4 v[128:131], v150, s[12:15], s26 offen
    s_add_u32 s26, s26, 2048
    s_waitcnt vmcnt(10)
    v_mfma_f32_32x32x16_bf16 v[12:27], v[100:103], v[132:135], v[12:27]
    buffer_load_dwordx4 v[100:103], v155, s[16:19], s27 offen offset:0
    s_add_u32 s27, s27, 81920
    s_waitcnt vmcnt(10)
    v_mfma_f32_32x32x16_bf16 v[28:43], v[104:107], v[132:135], v[28:43]
    buffer_load_dwordx4 v[104:107], v151, s[16:19], s27 offen offset:0
    s_waitcnt vmcnt(10)
    v_mfma_f32_32x32x16_bf16 v[44:59], v[108:111], v[132:135], v[44:59]
    buffer_load_dwordx4 v[108:111], v151, s[16:19], s27 offen offset:2048
    s_waitcnt vmcnt(10)
    v_mfma_f32_32x32x16_bf16 v[60:75], v[112:115], v[132:135], v[60:75]
    buffer_load_dwordx4 v[112:115], v154, s[16:19], s27 offen offset:0
    s_waitcnt vmcnt(9)
    v_mfma_f32_32x32x16_bf16 v[76:91], v[116:119], v[132:135], v[76:91]
    buffer_load_dwordx4 v[116:119], v154, s[16:19], s27 offen offset:2048
    buffer_load_dwordx4 v[132:135], v150, s[12:15], s26 offen
    s_add_u32 s26, s26, 2048
    s_waitcnt vmcnt(10)
    v_mfma_f32_32x32x16_bf16 v[12:27], v[120:123], v[136:139], v[12:27]
    buffer_load_dwordx4 v[120:123], v155, s[16:19], s27 offen offset:0
    s_add_u32 s27, s27, 81920
    s_waitcnt vmcnt(10)
    v_mfma_f32_32x32x16_bf16 v[28:43], v[124:127], v[136:139], v[28:43]
    buffer_load_dwordx4 v[124:127], v151, s[16:19], s27 offen offset:0
    s_waitcnt vmcnt(10)
    v_mfma_f32_32x32x16_bf16 v[44:59], v[92:95], v[136:139], v[44:59]
    buffer_load_dwordx4 v[92:95], v151, s[16:19], s27 offen offset:2048
    s_waitcnt vmcnt(10)
    v_mfma_f32_32x32x16_bf16 v[60:75], v[96:99], v[136:139], v[60:75]
    buffer_load_dwordx4 v[96:99], v154, s[16:19], s27 offen offset:0
    s_waitcnt vmcnt(9)
    v_mfma_f32_32x32x16_bf16 v[76:91], v[100:103], v[136:139], v[76:91]
    buffer_load_dwordx4 v[100:103], v154, s[16:19], s27 offen offset:2048
    buffer_load_dwordx4 v[136:139], v150, s[12:15], s26 offen
    s_add_u32 s26, s26, 2048
    s_waitcnt vmcnt(10)
    v_mfma_f32_32x32x16_bf16 v[12:27], v[104:107], v[128:131], v[12:27]
    buffer_load_dwordx4 v[104:107], v155, s[16:19], s27 offen offset:0
    s_add_u32 s27, s27, 81920
    s_waitcnt vmcnt(10)
    v_mfma_f32_32x32x16_bf16 v[28:43], v[108:111], v[128:131], v[28:43]
    buffer_load_dwordx4 v[108:111], v151, s[16:19], s27 offen offset:0
    s_waitcnt vmcnt(10)
    v_mfma_f32_32x32x16_bf16 v[44:59], v[112:115], v[128:131], v[44:59]
    buffer_load_dwordx4 v[112:115], v151, s[16:19], s27 offen offset:2048
    s_waitcnt vmcnt(10)
    v_mfma_f32_32x32x16_bf16 v[60:75], v[116:119], v[128:131], v[60:75]
    buffer_load_dwordx4 v[116:119], v154, s[16:19], s27 offen offset:0
    s_waitcnt vmcnt(9)
    v_mfma_f32_32x32x16_bf16 v[76:91], v[120:123], v[128:131], v[76:91]
    buffer_load_dwordx4 v[120:123], v154, s[16:19], s27 offen offset:2048
    s_add_u32 s38, s49, 81920
    buffer_load_dwordx4 v[128:131], v164, s[16:19], s38 offen offset:64
    s_waitcnt vmcnt(10)
    v_mfma_f32_32x32x16_bf16 v[12:27], v[124:127], v[132:135], v[12:27]
    buffer_load_dwordx4 v[124:127], v155, s[16:19], s27 offen offset:0
    s_add_u32 s27, s27, 81920
    s_waitcnt vmcnt(10)
    v_mfma_f32_32x32x16_bf16 v[28:43], v[92:95], v[132:135], v[28:43]
    s_add_u32 s38, s49, 0
    buffer_load_dwordx4 v[92:95], v164, s[16:19], s38 offen offset:0
    s_waitcnt vmcnt(10)
    v_mfma_f32_32x32x16_bf16 v[44:59], v[96:99], v[132:135], v[44:59]
    s_add_u32 s38, s49, 0
    buffer_load_dwordx4 v[96:99], v164, s[16:19], s38 offen offset:64
    s_waitcnt vmcnt(10)
    v_mfma_f32_32x32x16_bf16 v[60:75], v[100:103], v[132:135], v[60:75]
    s_add_u32 s38, s48, 40960
    buffer_load_dwordx4 v[100:103], v164, s[16:19], s38 offen offset:0
    s_waitcnt vmcnt(9)
    v_mfma_f32_32x32x16_bf16 v[76:91], v[104:107], v[132:135], v[76:91]
    s_add_u32 s38, s48, 40960
    buffer_load_dwordx4 v[104:107], v164, s[16:19], s38 offen offset:64
    s_add_u32 s38, s48, 122880
    buffer_load_dwordx4 v[132:135], v164, s[16:19], s38 offen offset:0
    s_waitcnt vmcnt(10)
    v_mfma_f32_32x32x16_bf16 v[12:27], v[108:111], v[136:139], v[12:27]
    s_add_u32 s38, s49, 40960
    buffer_load_dwordx4 v[108:111], v164, s[16:19], s38 offen offset:0
    s_waitcnt vmcnt(10)
    v_mfma_f32_32x32x16_bf16 v[28:43], v[112:115], v[136:139], v[28:43]
    s_add_u32 s38, s49, 40960
    buffer_load_dwordx4 v[112:115], v164, s[16:19], s38 offen offset:64
    s_waitcnt vmcnt(10)
    v_mfma_f32_32x32x16_bf16 v[44:59], v[116:119], v[136:139], v[44:59]
    s_add_u32 s38, s48, 81920
    buffer_load_dwordx4 v[116:119], v164, s[16:19], s38 offen offset:0
    s_waitcnt vmcnt(10)
    v_mfma_f32_32x32x16_bf16 v[60:75], v[120:123], v[136:139], v[60:75]
    s_add_u32 s38, s48, 81920
    buffer_load_dwordx4 v[120:123], v164, s[16:19], s38 offen offset:64
    s_waitcnt vmcnt(9)
    v_mfma_f32_32x32x16_bf16 v[76:91], v[124:127], v[136:139], v[76:91]
    s_add_u32 s38, s49, 81920
    buffer_load_dwordx4 v[124:127], v164, s[16:19], s38 offen offset:0
    s_add_u32 s38, s48, 122880
    buffer_load_dwordx4 v[136:139], v164, s[16:19], s38 offen offset:64
    s_nop 4
    s_setprio 3
    v_add_u32 v5, s45, v0
    ds_write_b128 v5, v[16:19] offset:0
    ds_write_b128 v5, v[32:35] offset:1024
    ds_write_b128 v5, v[48:51] offset:2048
    ds_write_b128 v5, v[64:67] offset:3072
    ds_write_b128 v5, v[80:83] offset:4096
    v_add_u32 v5, s46, v0
    ds_write_b128 v5, v[20:23] offset:0
    ds_write_b128 v5, v[36:39] offset:1024
    ds_write_b128 v5, v[52:55] offset:2048
    ds_write_b128 v5, v[68:71] offset:3072
    ds_write_b128 v5, v[84:87] offset:4096
    v_add_u32 v5, s47, v0
    ds_write_b128 v5, v[24:27] offset:0
    ds_write_b128 v5, v[40:43] offset:1024
    ds_write_b128 v5, v[56:59] offset:2048
    ds_write_b128 v5, v[72:75] offset:3072
    ds_write_b128 v5, v[88:91] offset:4096
    v_mov_b32 v5, 1
    s_mov_b64 exec, 1
    ds_add_u32 v3, v5 offset:4
    s_mov_b64 exec, -1
    s_add_u32 s38, s48, s86
    buffer_load_dwordx4 v[152:155], v164, s[16:19], s38 offen offset:64
    s_add_u32 s38, s49, s86
    buffer_load_dwordx4 v[156:159], v164, s[16:19], s38 offen offset:0
    s_waitcnt vmcnt(8)
    buffer_load_dwordx4 v[160:163], v164, s[16:19], s38 offen offset:64
k2_gspin:
    ds_read_b32 v5, v3 offset:4
    s_waitcnt lgkmcnt(0)
    v_readfirstlane_b32 s38, v5
    s_cmp_lt_u32 s38, 4
    s_cbranch_scc1 k2_gspin
    ds_read_b128 v[16:19], v2 offset:0
    ds_read_b128 v[32:35], v2 offset:1024
    ds_read_b128 v[48:51], v2 offset:2048
    ds_read_b128 v[64:67], v2 offset:3072
    ds_read_b128 v[80:83], v2 offset:4096
    ds_read_b128 v[20:23], v2 offset:5120
    ds_read_b128 v[36:39], v2 offset:6144
    ds_read_b128 v[52:55], v2 offset:7168
    ds_read_b128 v[68:71], v2 offset:8192
    ds_read_b128 v[84:87], v2 offset:9216
    ds_read_b128 v[24:27], v2 offset:10240
    ds_read_b128 v[40:43], v2 offset:11264
    ds_read_b128 v[56:59], v2 offset:12288
    ds_read_b128 v[72:75], v2 offset:13312
    ds_read_b128 v[88:91], v2 offset:14336
    v_mul_f32 v166, 0x3fe15c9b, v166
    s_waitcnt lgkmcnt(10)
    v_pk_add_f32 v[12:13], v[12:13], v[16:17]
    v_pk_add_f32 v[14:15], v[14:15], v[18:19]
    v_pk_add_f32 v[28:29], v[28:29], v[32:33]
    v_pk_add_f32 v[30:31], v[30:31], v[34:35]
    v_pk_add_f32 v[44:45], v[44:45], v[48:49]
    v_pk_add_f32 v[46:47], v[46:47], v[50:51]
    v_pk_add_f32 v[60:61], v[60:61], v[64:65]
    v_pk_add_f32 v[62:63], v[62:63], v[66:67]
    v_pk_add_f32 v[76:77], v[76:77], v[80:81]
    v_pk_add_f32 v[78:79], v[78:79], v[82:83]
    s_waitcnt lgkmcnt(5)
    v_pk_add_f32 v[12:13], v[12:13], v[20:21]
    v_pk_add_f32 v[14:15], v[14:15], v[22:23]
    v_pk_add_f32 v[28:29], v[28:29], v[36:37]
    v_pk_add_f32 v[30:31], v[30:31], v[38:39]
    v_pk_add_f32 v[44:45], v[44:45], v[52:53]
    v_pk_add_f32 v[46:47], v[46:47], v[54:55]
    v_pk_add_f32 v[60:61], v[60:61], v[68:69]
    v_pk_add_f32 v[62:63], v[62:63], v[70:71]
    v_pk_add_f32 v[76:77], v[76:77], v[84:85]
    v_pk_add_f32 v[78:79], v[78:79], v[86:87]
    s_waitcnt lgkmcnt(0)
    v_pk_add_f32 v[12:13], v[12:13], v[24:25]
    v_pk_add_f32 v[14:15], v[14:15], v[26:27]
    v_pk_add_f32 v[28:29], v[28:29], v[40:41]
    v_pk_add_f32 v[30:31], v[30:31], v[42:43]
    v_pk_add_f32 v[44:45], v[44:45], v[56:57]
    v_pk_add_f32 v[46:47], v[46:47], v[58:59]
    v_pk_add_f32 v[60:61], v[60:61], v[72:73]
    v_pk_add_f32 v[62:63], v[62:63], v[74:75]
    v_pk_add_f32 v[76:77], v[76:77], v[88:89]
    v_pk_add_f32 v[78:79], v[78:79], v[90:91]
    s_add_u32 m0, s76, 5120
    s_add_u32 s38, s75, 0
    buffer_load_dwordx4 v164, s[16:19], s38 offen lds
    v_lshlrev_b32 v16, 16, v140
    v_and_b32 v17, 0xffff0000, v140
    v_lshlrev_b32 v18, 16, v141
    v_and_b32 v19, 0xffff0000, v141
    v_pk_fma_f32 v[12:13], v[12:13], v[166:167], v[16:17] op_sel_hi:[1,0,1]
    v_pk_fma_f32 v[14:15], v[14:15], v[166:167], v[18:19] op_sel_hi:[1,0,1]
    ds_write_b128 v2, v[12:15] offset:0
    s_waitcnt vmcnt(8)
    s_add_u32 m0, s76, 6144
    s_nop 0
    buffer_load_dwordx4 v165, s[16:19], s38 offen lds
    v_lshlrev_b32 v32, 16, v142
    v_and_b32 v33, 0xffff0000, v142
    v_lshlrev_b32 v34, 16, v143
    v_and_b32 v35, 0xffff0000, v143
    v_pk_fma_f32 v[28:29], v[28:29], v[166:167], v[32:33] op_sel_hi:[1,0,1]
    v_pk_fma_f32 v[30:31], v[30:31], v[166:167], v[34:35] op_sel_hi:[1,0,1]
    ds_write_b128 v2, v[28:31] offset:1024
    s_add_u32 m0, s76, 7168
    s_add_u32 s38, s75, 40960
    buffer_load_dwordx4 v164, s[16:19], s38 offen lds
    v_lshlrev_b32 v48, 16, v144
    v_and_b32 v49, 0xffff0000, v144
    v_lshlrev_b32 v50, 16, v145
    v_and_b32 v51, 0xffff0000, v145
    v_pk_fma_f32 v[44:45], v[44:45], v[166:167], v[48:49] op_sel_hi:[1,0,1]
    v_pk_fma_f32 v[46:47], v[46:47], v[166:167], v[50:51] op_sel_hi:[1,0,1]
    ds_write_b128 v2, v[44:47] offset:2048
    s_waitcnt vmcnt(8)
    s_add_u32 m0, s76, 8192
    s_nop 0
    buffer_load_dwordx4 v165, s[16:19], s38 offen lds
    v_lshlrev_b32 v64, 16, v146
    v_and_b32 v65, 0xffff0000, v146
    v_lshlrev_b32 v66, 16, v147
    v_and_b32 v67, 0xffff0000, v147
    v_pk_fma_f32 v[60:61], v[60:61], v[166:167], v[64:65] op_sel_hi:[1,0,1]
    v_pk_fma_f32 v[62:63], v[62:63], v[166:167], v[66:67] op_sel_hi:[1,0,1]
    ds_write_b128 v2, v[60:63] offset:3072
    s_add_u32 m0, s76, 9216
    s_add_u32 s38, s75, 81920
    buffer_load_dwordx4 v164, s[16:19], s38 offen lds
    v_lshlrev_b32 v80, 16, v148
    v_and_b32 v81, 0xffff0000, v148
    v_lshlrev_b32 v82, 16, v149
    v_and_b32 v83, 0xffff0000, v149
    v_pk_fma_f32 v[76:77], v[76:77], v[166:167], v[80:81] op_sel_hi:[1,0,1]
    v_pk_fma_f32 v[78:79], v[78:79], v[166:167], v[82:83] op_sel_hi:[1,0,1]
    ds_write_b128 v2, v[76:79] offset:4096
    s_waitcnt vmcnt(8)
    s_add_u32 m0, s76, 10240
    s_nop 0
    buffer_load_dwordx4 v165, s[16:19], s38 offen lds
    s_add_u32 m0, s76, 11264
    s_add_u32 s38, s75, 122880
    buffer_load_dwordx4 v164, s[16:19], s38 offen lds
    s_waitcnt vmcnt(8)
    s_add_u32 m0, s76, 12288
    s_nop 0
    buffer_load_dwordx4 v165, s[16:19], s38 offen lds
    s_add_u32 m0, s76, 13312
    s_add_u32 s38, s75, s86
    buffer_load_dwordx4 v164, s[16:19], s38 offen lds
    s_waitcnt vmcnt(8)
    s_add_u32 m0, s76, 14336
    s_nop 0
    buffer_load_dwordx4 v165, s[16:19], s38 offen lds
    s_add_u32 s38, s48, 0
    buffer_load_dwordx4 v[84:87], v164, s[16:19], s38 offen offset:0
    s_waitcnt vmcnt(8)
    buffer_load_dwordx4 v[88:91], v164, s[16:19], s38 offen offset:64
    s_add_u32 s38, s49, 122880
    buffer_load_dwordx4 v[140:143], v164, s[16:19], s38 offen offset:0
    s_waitcnt vmcnt(8)
    buffer_load_dwordx4 v[144:147], v164, s[16:19], s38 offen offset:64
    s_add_u32 s38, s48, s86
    buffer_load_dwordx4 v[148:151], v164, s[16:19], s38 offen offset:0
    s_waitcnt vmcnt(8)
    v_lshrrev_b32 v5, 1, v0
    v_add_u32 v164, s72, v0
    v_add_u32 v166, s72, v5
    v_add_u32 v165, s73, v0
    v_add_u32 v167, s73, v5
    s_waitcnt lgkmcnt(0)
    v_pk_mov_b32 v[20:21], 0, 0
    v_pk_mov_b32 v[22:23], 0, 0
    v_pk_mov_b32 v[24:25], 0, 0
    v_pk_mov_b32 v[26:27], 0, 0
    v_pk_mov_b32 v[28:29], 0, 0
    v_pk_mov_b32 v[30:31], 0, 0
    v_pk_mov_b32 v[32:33], 0, 0
    v_pk_mov_b32 v[34:35], 0, 0
    v_pk_mov_b32 v[36:37], 0, 0
    v_pk_mov_b32 v[38:39], 0, 0
    v_pk_mov_b32 v[40:41], 0, 0
    v_pk_mov_b32 v[42:43], 0, 0
    s_barrier
    ds_read_b128 v[12:15], v1 offset:0
    ds_read_b128 v[16:19], v1 offset:512
    s_barrier
    s_waitcnt vmcnt(0)
    s_barrier
    ds_read_b32 v5, v3
    s_waitcnt lgkmcnt(0)
    v_readfirstlane_b32 s38, v5
    s_cmp_eq_u32 s38, 0
    s_cbranch_scc1 k2_gp
    s_waitcnt vmcnt(0)
    s_barrier
    s_barrier
    s_barrier
    s_barrier
    s_barrier
k2_gp:
    s_barrier
    s_mov_b32 m0, s72
    s_nop 0
    buffer_load_dwordx4 v0, s[68:71], s41 offen offset:0 sc1 lds
    buffer_load_dwordx4 v0, s[68:71], s41 offen offset:1024 sc1 lds
    buffer_load_dwordx4 v0, s[68:71], s41 offen offset:2048 sc1 lds
    buffer_load_dwordx4 v0, s[68:71], s41 offen offset:3072 sc1 lds
    s_mov_b32 m0, s73
    s_nop 0
    buffer_load_dwordx4 v0, s[68:71], s42 offen offset:0 sc1 lds
    buffer_load_dwordx4 v0, s[68:71], s42 offen offset:1024 sc1 lds
    buffer_load_dwordx4 v0, s[68:71], s42 offen offset:2048 sc1 lds
    buffer_load_dwordx4 v0, s[68:71], s42 offen offset:3072 sc1 lds
    s_add_u32 m0, s72, 4096
    s_nop 0
    buffer_load_dwordx4 v0, s[68:71], s43 offen offset:0 sc1 lds
    s_add_u32 m0, s73, 4096
    s_nop 0
    buffer_load_dwordx4 v0, s[68:71], s44 offen offset:0 sc1 lds
    s_waitcnt vmcnt(0)
    s_barrier
    ds_read_b128 v[44:47], v164 offset:0
    ds_read_b128 v[48:51], v165 offset:0
    ds_read_b128 v[52:55], v164 offset:1024
    ds_read_b128 v[56:59], v165 offset:1024
    ds_read_b128 v[60:63], v164 offset:2048
    ds_read_b128 v[64:67], v165 offset:2048
    ds_read_b128 v[68:71], v164 offset:3072
    ds_read_b128 v[72:75], v165 offset:3072
    ds_read_b64 v[76:77], v166 offset:4096
    ds_read_b64 v[78:79], v166 offset:4608
    ds_read_b64 v[80:81], v167 offset:4096
    ds_read_b64 v[82:83], v167 offset:4608
    s_waitcnt lgkmcnt(11)
    v_max3_u32 v5, v44, v45, v46
    v_max_u32 v5, v5, v47
    v_cmp_eq_u32 vcc, -1, v5
    s_cbranch_vccnz k2G_m0
    v_mfma_f32_16x16x32_bf16 v[12:15], v[84:87], v[44:47], v[12:15]
    v_mfma_f32_16x16x32_bf16 v[16:19], v[88:91], v[44:47], v[16:19]
    v_mfma_f32_16x16x32_bf16 v[20:23], v[92:95], v[44:47], v[20:23]
    v_mfma_f32_16x16x32_bf16 v[24:27], v[96:99], v[44:47], v[24:27]
    s_bitset0_b32 s81, 0
k2G_n0:
    s_waitcnt lgkmcnt(10)
    v_max3_u32 v5, v48, v49, v50
    v_max_u32 v5, v5, v51
    v_cmp_eq_u32 vcc, -1, v5
    s_cbranch_vccnz k2G_m1
    v_mfma_f32_16x16x32_bf16 v[28:31], v[84:87], v[48:51], v[28:31]
    v_mfma_f32_16x16x32_bf16 v[32:35], v[88:91], v[48:51], v[32:35]
    v_mfma_f32_16x16x32_bf16 v[36:39], v[92:95], v[48:51], v[36:39]
    v_mfma_f32_16x16x32_bf16 v[40:43], v[96:99], v[48:51], v[40:43]
    s_bitset0_b32 s81, 1
k2G_n1:
    s_waitcnt lgkmcnt(9)
    v_max3_u32 v5, v52, v53, v54
    v_max_u32 v5, v5, v55
    v_cmp_eq_u32 vcc, -1, v5
    s_cbranch_vccnz k2G_m2
    v_mfma_f32_16x16x32_bf16 v[12:15], v[100:103], v[52:55], v[12:15]
    v_mfma_f32_16x16x32_bf16 v[16:19], v[104:107], v[52:55], v[16:19]
    v_mfma_f32_16x16x32_bf16 v[20:23], v[108:111], v[52:55], v[20:23]
    v_mfma_f32_16x16x32_bf16 v[24:27], v[112:115], v[52:55], v[24:27]
    s_bitset0_b32 s81, 2
k2G_n2:
    s_waitcnt lgkmcnt(8)
    v_max3_u32 v5, v56, v57, v58
    v_max_u32 v5, v5, v59
    v_cmp_eq_u32 vcc, -1, v5
    s_cbranch_vccnz k2G_m3
    v_mfma_f32_16x16x32_bf16 v[28:31], v[100:103], v[56:59], v[28:31]
    v_mfma_f32_16x16x32_bf16 v[32:35], v[104:107], v[56:59], v[32:35]
    v_mfma_f32_16x16x32_bf16 v[36:39], v[108:111], v[56:59], v[36:39]
    v_mfma_f32_16x16x32_bf16 v[40:43], v[112:115], v[56:59], v[40:43]
    s_bitset0_b32 s81, 3
k2G_n3:
    s_waitcnt lgkmcnt(7)
    v_max3_u32 v5, v60, v61, v62
    v_max_u32 v5, v5, v63
    v_cmp_eq_u32 vcc, -1, v5
    s_cbranch_vccnz k2G_m4
    v_mfma_f32_16x16x32_bf16 v[12:15], v[116:119], v[60:63], v[12:15]
    v_mfma_f32_16x16x32_bf16 v[16:19], v[120:123], v[60:63], v[16:19]
    v_mfma_f32_16x16x32_bf16 v[20:23], v[124:127], v[60:63], v[20:23]
    v_mfma_f32_16x16x32_bf16 v[24:27], v[128:131], v[60:63], v[24:27]
    s_bitset0_b32 s81, 4
k2G_n4:
    s_waitcnt lgkmcnt(6)
    v_max3_u32 v5, v64, v65, v66
    v_max_u32 v5, v5, v67
    v_cmp_eq_u32 vcc, -1, v5
    s_cbranch_vccnz k2G_m5
    v_mfma_f32_16x16x32_bf16 v[28:31], v[116:119], v[64:67], v[28:31]
    v_mfma_f32_16x16x32_bf16 v[32:35], v[120:123], v[64:67], v[32:35]
    v_mfma_f32_16x16x32_bf16 v[36:39], v[124:127], v[64:67], v[36:39]
    v_mfma_f32_16x16x32_bf16 v[40:43], v[128:131], v[64:67], v[40:43]
    s_bitset0_b32 s81, 5
k2G_n5:
    s_waitcnt lgkmcnt(5)
    v_max3_u32 v5, v68, v69, v70
    v_max_u32 v5, v5, v71
    v_cmp_eq_u32 vcc, -1, v5
    s_cbranch_vccnz k2G_m6
    v_mfma_f32_16x16x32_bf16 v[12:15], v[132:135], v[68:71], v[12:15]
    v_mfma_f32_16x16x32_bf16 v[16:19], v[136:139], v[68:71], v[16:19]
    v_mfma_f32_16x16x32_bf16 v[20:23], v[140:143], v[68:71], v[20:23]
    v_mfma_f32_16x16x32_bf16 v[24:27], v[144:147], v[68:71], v[24:27]
    s_bitset0_b32 s81, 6
k2G_n6:
    s_waitcnt lgkmcnt(4)
    v_max3_u32 v5, v72, v73, v74
    v_max_u32 v5, v5, v75
    v_cmp_eq_u32 vcc, -1, v5
    s_cbranch_vccnz k2G_m7
    v_mfma_f32_16x16x32_bf16 v[28:31], v[132:135], v[72:75], v[28:31]
    v_mfma_f32_16x16x32_bf16 v[32:35], v[136:139], v[72:75], v[32:35]
    v_mfma_f32_16x16x32_bf16 v[36:39], v[140:143], v[72:75], v[36:39]
    v_mfma_f32_16x16x32_bf16 v[40:43], v[144:147], v[72:75], v[40:43]
    s_bitset0_b32 s81, 7
k2G_n7:
    s_waitcnt lgkmcnt(2)
    v_max3_u32 v5, v76, v77, v78
    v_max_u32 v5, v5, v79
    v_cmp_eq_u32 vcc, -1, v5
    s_cbranch_vccnz k2G_m8
    v_mfma_f32_16x16x32_bf16 v[12:15], v[148:151], v[76:79], v[12:15]
    v_mfma_f32_16x16x32_bf16 v[16:19], v[152:155], v[76:79], v[16:19]
    v_mfma_f32_16x16x32_bf16 v[20:23], v[156:159], v[76:79], v[20:23]
    v_mfma_f32_16x16x32_bf16 v[24:27], v[160:163], v[76:79], v[24:27]
    s_bitset0_b32 s81, 8
k2G_n8:
    s_waitcnt lgkmcnt(0)
    v_max3_u32 v5, v80, v81, v82
    v_max_u32 v5, v5, v83
    v_cmp_eq_u32 vcc, -1, v5
    s_cbranch_vccnz k2G_m9
    v_mfma_f32_16x16x32_bf16 v[28:31], v[148:151], v[80:83], v[28:31]
    v_mfma_f32_16x16x32_bf16 v[32:35], v[152:155], v[80:83], v[32:35]
    v_mfma_f32_16x16x32_bf16 v[36:39], v[156:159], v[80:83], v[36:39]
    v_mfma_f32_16x16x32_bf16 v[40:43], v[160:163], v[80:83], v[40:43]
    s_bitset0_b32 s81, 9
k2G_n9:
    s_cmp_lg_u32 s81, 0
    s_cbranch_scc1 k2G_slow0
k2G_done:
    s_nop 5
    ds_write_b128 v6, v[20:23] offset:0
    ds_write_b128 v6, v[24:27] offset:1024
    ds_write_b128 v7, v[28:31] offset:0
    ds_write_b128 v7, v[32:35] offset:1024
    ds_write_b128 v8, v[36:39] offset:0
    ds_write_b128 v8, v[40:43] offset:1024
    s_waitcnt lgkmcnt(0)
    s_barrier
    ds_read_b128 v[44:47], v9 offset:0
    ds_read_b128 v[48:51], v9 offset:1024
    ds_read_b128 v[52:55], v9 offset:2048
    ds_read_b128 v[56:59], v9 offset:3072
    ds_read_b128 v[60:63], v9 offset:4096
    ds_read_b128 v[64:67], v9 offset:5120
    s_waitcnt lgkmcnt(4)
    v_pk_add_f32 v[12:13], v[12:13], v[44:45]
    v_pk_add_f32 v[14:15], v[14:15], v[46:47]
    v_pk_add_f32 v[16:17], v[16:17], v[48:49]
    v_pk_add_f32 v[18:19], v[18:19], v[50:51]
    s_waitcnt lgkmcnt(2)
    v_pk_add_f32 v[12:13], v[12:13], v[52:53]
    v_pk_add_f32 v[14:15], v[14:15], v[54:55]
    v_pk_add_f32 v[16:17], v[16:17], v[56:57]
    v_pk_add_f32 v[18:19], v[18:19], v[58:59]
    s_waitcnt lgkmcnt(0)
    v_pk_add_f32 v[12:13], v[12:13], v[60:61]
    v_pk_add_f32 v[14:15], v[14:15], v[62:63]
    v_pk_add_f32 v[16:17], v[16:17], v[64:65]
    v_pk_add_f32 v[18:19], v[18:19], v[66:67]
    v_cvt_pk_bf16_f32 v12, v12, v13
    v_cvt_pk_bf16_f32 v13, v14, v15
    v_cvt_pk_bf16_f32 v14, v16, v17
    v_cvt_pk_bf16_f32 v15, v18, v19
    buffer_store_dwordx4 v[12:15], v4, s[60:63], s87 offen sc0 sc1
    s_waitcnt vmcnt(0)
    s_endpgm
k2G_m0:
    s_mov_b32 m0, s72
    s_nop 0
    buffer_load_dwordx4 v0, s[68:71], s41 offen offset:0 sc1 lds
    s_branch k2G_n0
k2G_m1:
    s_mov_b32 m0, s73
    s_nop 0
    buffer_load_dwordx4 v0, s[68:71], s42 offen offset:0 sc1 lds
    s_branch k2G_n1
k2G_m2:
    s_mov_b32 m0, s72
    s_nop 0
    buffer_load_dwordx4 v0, s[68:71], s41 offen offset:1024 sc1 lds
    s_branch k2G_n2
k2G_m3:
    s_mov_b32 m0, s73
    s_nop 0
    buffer_load_dwordx4 v0, s[68:71], s42 offen offset:1024 sc1 lds
    s_branch k2G_n3
k2G_m4:
    s_mov_b32 m0, s72
    s_nop 0
    buffer_load_dwordx4 v0, s[68:71], s41 offen offset:2048 sc1 lds
    s_branch k2G_n4
k2G_m5:
    s_mov_b32 m0, s73
    s_nop 0
    buffer_load_dwordx4 v0, s[68:71], s42 offen offset:2048 sc1 lds
    s_branch k2G_n5
k2G_m6:
    s_mov_b32 m0, s72
    s_nop 0
    buffer_load_dwordx4 v0, s[68:71], s41 offen offset:3072 sc1 lds
    s_branch k2G_n6
k2G_m7:
    s_mov_b32 m0, s73
    s_nop 0
    buffer_load_dwordx4 v0, s[68:71], s42 offen offset:3072 sc1 lds
    s_branch k2G_n7
k2G_m8:
    s_add_u32 m0, s72, 4096
    s_nop 0
    buffer_load_dwordx4 v0, s[68:71], s43 offen offset:0 sc1 lds
    s_branch k2G_n8
k2G_m9:
    s_add_u32 m0, s73, 4096
    s_nop 0
    buffer_load_dwordx4 v0, s[68:71], s44 offen offset:0 sc1 lds
    s_branch k2G_n9
k2G_slow0:
    s_and_b32 s38, s81, 15
    s_cbranch_scc0 k2G_g10
    s_bitcmp1_b32 s81, 0
    s_cbranch_scc0 k2G_s10
    ds_read_b128 v[44:47], v164 offset:0
    s_mov_b32 m0, s72
    s_nop 0
    buffer_load_dwordx4 v0, s[68:71], s41 offen offset:0 sc1 lds
    s_waitcnt lgkmcnt(0)
    v_max3_u32 v5, v44, v45, v46
    v_max_u32 v5, v5, v47
    v_cmp_eq_u32 vcc, -1, v5
    s_cbranch_vccnz k2G_s10
    v_mfma_f32_16x16x32_bf16 v[12:15], v[84:87], v[44:47], v[12:15]
    v_mfma_f32_16x16x32_bf16 v[16:19], v[88:91], v[44:47], v[16:19]
    v_mfma_f32_16x16x32_bf16 v[20:23], v[92:95], v[44:47], v[20:23]
    v_mfma_f32_16x16x32_bf16 v[24:27], v[96:99], v[44:47], v[24:27]
    s_bitset0_b32 s81, 0
k2G_s10:
    s_bitcmp1_b32 s81, 1
    s_cbranch_scc0 k2G_s11
    ds_read_b128 v[48:51], v165 offset:0
    s_mov_b32 m0, s73
    s_nop 0
    buffer_load_dwordx4 v0, s[68:71], s42 offen offset:0 sc1 lds
    s_waitcnt lgkmcnt(0)
    v_max3_u32 v5, v48, v49, v50
    v_max_u32 v5, v5, v51
    v_cmp_eq_u32 vcc, -1, v5
    s_cbranch_vccnz k2G_s11
    v_mfma_f32_16x16x32_bf16 v[28:31], v[84:87], v[48:51], v[28:31]
    v_mfma_f32_16x16x32_bf16 v[32:35], v[88:91], v[48:51], v[32:35]
    v_mfma_f32_16x16x32_bf16 v[36:39], v[92:95], v[48:51], v[36:39]
    v_mfma_f32_16x16x32_bf16 v[40:43], v[96:99], v[48:51], v[40:43]
    s_bitset0_b32 s81, 1
k2G_s11:
    s_bitcmp1_b32 s81, 2
    s_cbranch_scc0 k2G_s12
    ds_read_b128 v[52:55], v164 offset:1024
    s_mov_b32 m0, s72
    s_nop 0
    buffer_load_dwordx4 v0, s[68:71], s41 offen offset:1024 sc1 lds
    s_waitcnt lgkmcnt(0)
    v_max3_u32 v5, v52, v53, v54
    v_max_u32 v5, v5, v55
    v_cmp_eq_u32 vcc, -1, v5
    s_cbranch_vccnz k2G_s12
    v_mfma_f32_16x16x32_bf16 v[12:15], v[100:103], v[52:55], v[12:15]
    v_mfma_f32_16x16x32_bf16 v[16:19], v[104:107], v[52:55], v[16:19]
    v_mfma_f32_16x16x32_bf16 v[20:23], v[108:111], v[52:55], v[20:23]
    v_mfma_f32_16x16x32_bf16 v[24:27], v[112:115], v[52:55], v[24:27]
    s_bitset0_b32 s81, 2
k2G_s12:
    s_bitcmp1_b32 s81, 3
    s_cbranch_scc0 k2G_s13
    ds_read_b128 v[56:59], v165 offset:1024
    s_mov_b32 m0, s73
    s_nop 0
    buffer_load_dwordx4 v0, s[68:71], s42 offen offset:1024 sc1 lds
    s_waitcnt lgkmcnt(0)
    v_max3_u32 v5, v56, v57, v58
    v_max_u32 v5, v5, v59
    v_cmp_eq_u32 vcc, -1, v5
    s_cbranch_vccnz k2G_s13
    v_mfma_f32_16x16x32_bf16 v[28:31], v[100:103], v[56:59], v[28:31]
    v_mfma_f32_16x16x32_bf16 v[32:35], v[104:107], v[56:59], v[32:35]
    v_mfma_f32_16x16x32_bf16 v[36:39], v[108:111], v[56:59], v[36:39]
    v_mfma_f32_16x16x32_bf16 v[40:43], v[112:115], v[56:59], v[40:43]
    s_bitset0_b32 s81, 3
k2G_s13:
k2G_g10:
    s_and_b32 s38, s81, 240
    s_cbranch_scc0 k2G_g14
    s_bitcmp1_b32 s81, 4
    s_cbranch_scc0 k2G_s14
    ds_read_b128 v[60:63], v164 offset:2048
    s_mov_b32 m0, s72
    s_nop 0
    buffer_load_dwordx4 v0, s[68:71], s41 offen offset:2048 sc1 lds
    s_waitcnt lgkmcnt(0)
    v_max3_u32 v5, v60, v61, v62
    v_max_u32 v5, v5, v63
    v_cmp_eq_u32 vcc, -1, v5
    s_cbranch_vccnz k2G_s14
    v_mfma_f32_16x16x32_bf16 v[12:15], v[116:119], v[60:63], v[12:15]
    v_mfma_f32_16x16x32_bf16 v[16:19], v[120:123], v[60:63], v[16:19]
    v_mfma_f32_16x16x32_bf16 v[20:23], v[124:127], v[60:63], v[20:23]
    v_mfma_f32_16x16x32_bf16 v[24:27], v[128:131], v[60:63], v[24:27]
    s_bitset0_b32 s81, 4
k2G_s14:
    s_bitcmp1_b32 s81, 5
    s_cbranch_scc0 k2G_s15
    ds_read_b128 v[64:67], v165 offset:2048
    s_mov_b32 m0, s73
    s_nop 0
    buffer_load_dwordx4 v0, s[68:71], s42 offen offset:2048 sc1 lds
    s_waitcnt lgkmcnt(0)
    v_max3_u32 v5, v64, v65, v66
    v_max_u32 v5, v5, v67
    v_cmp_eq_u32 vcc, -1, v5
    s_cbranch_vccnz k2G_s15
    v_mfma_f32_16x16x32_bf16 v[28:31], v[116:119], v[64:67], v[28:31]
    v_mfma_f32_16x16x32_bf16 v[32:35], v[120:123], v[64:67], v[32:35]
    v_mfma_f32_16x16x32_bf16 v[36:39], v[124:127], v[64:67], v[36:39]
    v_mfma_f32_16x16x32_bf16 v[40:43], v[128:131], v[64:67], v[40:43]
    s_bitset0_b32 s81, 5
k2G_s15:
    s_bitcmp1_b32 s81, 6
    s_cbranch_scc0 k2G_s16
    ds_read_b128 v[68:71], v164 offset:3072
    s_mov_b32 m0, s72
    s_nop 0
    buffer_load_dwordx4 v0, s[68:71], s41 offen offset:3072 sc1 lds
    s_waitcnt lgkmcnt(0)
    v_max3_u32 v5, v68, v69, v70
    v_max_u32 v5, v5, v71
    v_cmp_eq_u32 vcc, -1, v5
    s_cbranch_vccnz k2G_s16
    v_mfma_f32_16x16x32_bf16 v[12:15], v[132:135], v[68:71], v[12:15]
    v_mfma_f32_16x16x32_bf16 v[16:19], v[136:139], v[68:71], v[16:19]
    v_mfma_f32_16x16x32_bf16 v[20:23], v[140:143], v[68:71], v[20:23]
    v_mfma_f32_16x16x32_bf16 v[24:27], v[144:147], v[68:71], v[24:27]
    s_bitset0_b32 s81, 6
k2G_s16:
    s_bitcmp1_b32 s81, 7
    s_cbranch_scc0 k2G_s17
    ds_read_b128 v[72:75], v165 offset:3072
    s_mov_b32 m0, s73
    s_nop 0
    buffer_load_dwordx4 v0, s[68:71], s42 offen offset:3072 sc1 lds
    s_waitcnt lgkmcnt(0)
    v_max3_u32 v5, v72, v73, v74
    v_max_u32 v5, v5, v75
    v_cmp_eq_u32 vcc, -1, v5
    s_cbranch_vccnz k2G_s17
    v_mfma_f32_16x16x32_bf16 v[28:31], v[132:135], v[72:75], v[28:31]
    v_mfma_f32_16x16x32_bf16 v[32:35], v[136:139], v[72:75], v[32:35]
    v_mfma_f32_16x16x32_bf16 v[36:39], v[140:143], v[72:75], v[36:39]
    v_mfma_f32_16x16x32_bf16 v[40:43], v[144:147], v[72:75], v[40:43]
    s_bitset0_b32 s81, 7
k2G_s17:
k2G_g14:
    s_and_b32 s38, s81, 768
    s_cbranch_scc0 k2G_g18
    s_bitcmp1_b32 s81, 8
    s_cbranch_scc0 k2G_s18
    ds_read_b64 v[76:77], v166 offset:4096
    ds_read_b64 v[78:79], v166 offset:4608
    s_add_u32 m0, s72, 4096
    s_nop 0
    buffer_load_dwordx4 v0, s[68:71], s43 offen offset:0 sc1 lds
    s_waitcnt lgkmcnt(0)
    v_max3_u32 v5, v76, v77, v78
    v_max_u32 v5, v5, v79
    v_cmp_eq_u32 vcc, -1, v5
    s_cbranch_vccnz k2G_s18
    v_mfma_f32_16x16x32_bf16 v[12:15], v[148:151], v[76:79], v[12:15]
    v_mfma_f32_16x16x32_bf16 v[16:19], v[152:155], v[76:79], v[16:19]
    v_mfma_f32_16x16x32_bf16 v[20:23], v[156:159], v[76:79], v[20:23]
    v_mfma_f32_16x16x32_bf16 v[24:27], v[160:163], v[76:79], v[24:27]
    s_bitset0_b32 s81, 8
k2G_s18:
    s_bitcmp1_b32 s81, 9
    s_cbranch_scc0 k2G_s19
    ds_read_b64 v[80:81], v167 offset:4096
    ds_read_b64 v[82:83], v167 offset:4608
    s_add_u32 m0, s73, 4096
    s_nop 0
    buffer_load_dwordx4 v0, s[68:71], s44 offen offset:0 sc1 lds
    s_waitcnt lgkmcnt(0)
    v_max3_u32 v5, v80, v81, v82
    v_max_u32 v5, v5, v83
    v_cmp_eq_u32 vcc, -1, v5
    s_cbranch_vccnz k2G_s19
    v_mfma_f32_16x16x32_bf16 v[28:31], v[148:151], v[80:83], v[28:31]
    v_mfma_f32_16x16x32_bf16 v[32:35], v[152:155], v[80:83], v[32:35]
    v_mfma_f32_16x16x32_bf16 v[36:39], v[156:159], v[80:83], v[36:39]
    v_mfma_f32_16x16x32_bf16 v[40:43], v[160:163], v[80:83], v[40:43]
    s_bitset0_b32 s81, 9
k2G_s19:
k2G_g18:
    s_cmp_eq_u32 s81, 0
    s_cbranch_scc1 k2G_done
    s_sub_u32 s82, s82, 1
    s_cbranch_scc0 k2G_slow0
    s_branch k2G_done
code_end:
.section .rodata,"a"
.p2align 6
.amdhsa_kernel attn_kernel
  .amdhsa_next_free_vgpr 168
  .amdhsa_next_free_sgpr 102
  .amdhsa_accum_offset 168
  .amdhsa_group_segment_fixed_size 0
  .amdhsa_kernarg_size 72
  .amdhsa_user_sgpr_count 2
  .amdhsa_user_sgpr_kernarg_segment_ptr 1
  .amdhsa_system_sgpr_workgroup_id_x 1
.end_amdhsa_kernel
```
